```python
import torch

def _softmax(x, axis=-1):
    return torch.softmax(x, dim=axis)
def _gelu(x):
    return torch.nn.functional.gelu(x, approximate="tanh")
def _silu(x):
    return torch.nn.functional.silu(x)
def _sigmoid(x):
    return torch.sigmoid(x)
def _layernorm(x, axis=-1, eps=1e-5):
    m = x.mean(dim=axis, keepdim=True)
    v = x.var(dim=axis, keepdim=True, unbiased=False)
    return (x - m) / torch.sqrt(v + eps)
def _scatter_add(tgt, idx, src, axis=0):
    return tgt.clone().index_add_(axis, idx, src)
def _segment_sum(src, seg, n):
    out = torch.zeros((n,) + src.shape[1:], dtype=src.dtype)
    return out.index_add_(0, seg, src)
def _pad(x, pw):
    flat = tuple(v for pair in reversed(pw) for v in pair)
    return torch.nn.functional.pad(x, flat)

kernel_name = 'gated_mix__grouped_kv_mqa__grouped_kv_mqa__prompt'

def setup_inputs():

    _w = (lambda a: (lambda t: t.to(torch.bfloat16) if t.is_floating_point() else t)(torch.as_tensor(a)))
    def _A_setup():
        B, S, D, H = 1, 2048, 1024, 32
        Dh = D // H
        return {
            "x": _w((lambda *s: torch.randn(*s, dtype=torch.bfloat16) * 0.05)(B, S, D)),
            "wq": _w((lambda *s: torch.randn(*s, dtype=torch.bfloat16) * 0.8)(D, H * Dh)),
            "wk": _w((lambda *s: torch.randn(*s, dtype=torch.bfloat16) * 0.8)(D, Dh)),
            "wv": _w((lambda *s: torch.randn(*s, dtype=torch.bfloat16) * 0.05)(D, Dh)),
            "wo": _w((lambda *s: torch.randn(*s, dtype=torch.bfloat16) * 0.05)(H * Dh, D)),
        }
    _A_in = _A_setup()

    def _B_setup():
        B, S, D, H = 1, 2048, 1024, 32
        Dh = D // H
        return {
            "x": _w((lambda *s: torch.randn(*s, dtype=torch.bfloat16) * 0.05)(B, S, D)),
            "wq": _w((lambda *s: torch.randn(*s, dtype=torch.bfloat16) * 0.8)(D, H * Dh)),
            "wk": _w((lambda *s: torch.randn(*s, dtype=torch.bfloat16) * 0.8)(D, Dh)),
            "wv": _w((lambda *s: torch.randn(*s, dtype=torch.bfloat16) * 0.05)(D, Dh)),
            "wo": _w((lambda *s: torch.randn(*s, dtype=torch.bfloat16) * 0.05)(H * Dh, D)),
        }
    _B_in = _B_setup()

    return {
        "A_x": _A_in["x"],
        "A_wq": _A_in["wq"],
        "A_wk": _A_in["wk"],
        "A_wv": _A_in["wv"],
        "A_wo": _A_in["wo"],
        "B_x": _B_in["x"],
        "B_wq": _B_in["wq"],
        "B_wk": _B_in["wk"],
        "B_wv": _B_in["wv"],
        "B_wo": _B_in["wo"],
        "gate_w": _w((lambda *s: torch.randn(*s, dtype=torch.bfloat16) * 0.05)(1024) * 16.0),
    }

def reference(A_x, A_wq, A_wk, A_wv, A_wo, B_x, B_wq, B_wk, B_wv, B_wo, gate_w):
    def _A_ref(x, wq, wk, wv, wo):
        B, S, D = x.shape
        H = 32
        Dh = D // H
        q = (lambda x, *d: x.permute(*d))((x @ wq).reshape(B, S, H, Dh), 0, 2, 1, 3)
        k = x @ wk
        v = x @ wv
        scores = torch.einsum("bhqd,bkd->bhqk", q, k) * (Dh ** -0.5)
        p = _softmax(scores, axis=-1)
        o = torch.einsum("bhqk,bkd->bhqd", p, v)
        return (lambda x, *d: x.permute(*d))(o, 0, 2, 1, 3).reshape(B, S, H * Dh) @ wo

    def _B_ref(x, wq, wk, wv, wo):
        B, S, D = x.shape
        H = 32
        Dh = D // H
        q = (lambda x, *d: x.permute(*d))((x @ wq).reshape(B, S, H, Dh), 0, 2, 1, 3)
        k = x @ wk
        v = x @ wv
        scores = torch.einsum("bhqd,bkd->bhqk", q, k) * (Dh ** -0.5)
        p = _softmax(scores, axis=-1)
        o = torch.einsum("bhqk,bkd->bhqd", p, v)
        return (lambda x, *d: x.permute(*d))(o, 0, 2, 1, 3).reshape(B, S, H * Dh) @ wo

    x = A_x
    g = _sigmoid((x * gate_w).sum(-1, keepdims=True))
    a = _A_ref(x, A_wq, A_wk, A_wv, A_wo)
    b = _B_ref(x, B_wq, B_wk, B_wv, B_wo)
    return g * a + (1 - g) * b
```

```asm
; @launch grid=(256,1,1) block=(256,1,1) lds=163840
.amdgcn_target "amdgcn-amd-amdhsa--gfx950"
.text
.globl gated_mix__grouped_kv_mqa__grouped_kv_mqa__prompt_kernel
.p2align 8
.type gated_mix__grouped_kv_mqa__grouped_kv_mqa__prompt_kernel,@function
gated_mix__grouped_kv_mqa__grouped_kv_mqa__prompt_kernel:
    s_cmp_ge_u32 s2, 256
    s_cbranch_scc1 L_at_end
    s_load_dwordx8 s[4:11], s[0:1], 0
    s_load_dwordx2 s[64:65], s[0:1], 32
    s_load_dwordx8 s[12:19], s[0:1], 48
    s_load_dwordx2 s[66:67], s[0:1], 80
    s_load_dwordx4 s[24:27], s[0:1], 96
    s_and_b32 s28, s2, 1
    s_bfe_u32 s29, s2, 0x20001
    s_bfe_u32 s30, s2, 0x20003
    s_lshl_b32 s29, s29, 2
    s_add_u32 s29, s29, s30
    s_lshr_b32 s30, s2, 5
    s_lshr_b32 s31, s2, 7
    s_and_b32 s23, s30, 3
    s_lshl_b32 s33, s29, 2
    s_add_u32 s33, s33, s23
    s_lshl_b32 s34, s31, 1
    s_add_u32 s34, s34, s23
    s_and_b32 s34, s34, 3
    s_lshl_b32 s37, s30, 1
    s_and_b32 s38, s29, 12
    s_add_u32 s37, s37, s38
    s_and_b32 s37, s37, 15
    s_lshl_b32 s38, s29, 18
    s_lshl_b32 s39, s30, 8
    v_lshrrev_b32 v4, 6, v0
    v_and_b32 v1, 63, v0
    v_readfirstlane_b32 s20, v4
    v_lshrrev_b32 v2, 5, v1
    v_and_b32 v3, 31, v1
    v_lshlrev_b32 v28, 4, v1
    v_lshl_add_u32 v29, v4, 12, v28
    v_lshrrev_b32 v24, 3, v1
    v_lshl_add_u32 v24, v4, 5, v24
    v_lshlrev_b32 v24, 11, v24
    v_lshrrev_b32 v25, 4, v1
    v_and_b32 v5, 7, v1
    v_xor_b32 v5, v5, v25
    v_lshl_add_u32 v8, v5, 4, v24
    v_xor_b32 v9, 64, v8
    v_add_u32 v9, 15360, v9
    v_add_u32 v10, 30720, v8
    v_add_u32 v11, 30720, v9
    v_lshl_add_u32 v24, v4, 4, v25
    v_lshlrev_b32 v24, 11, v24
    v_lshlrev_b32 v25, 2, v25
    v_and_b32 v5, 15, v1
    v_xor_b32 v5, v5, v25
    v_lshl_add_u32 v12, v5, 4, v24
    v_add_u32 v13, 7168, v12
    v_add_u32 v14, 14336, v12
    v_add_u32 v15, 21504, v12
    s_waitcnt lgkmcnt(0)
    s_cmp_eq_u32 s28, 1
    s_cselect_b64 s[6:7], s[12:13], s[6:7]
    s_cselect_b64 s[8:9], s[14:15], s[8:9]
    s_cselect_b64 s[10:11], s[16:17], s[10:11]
    s_cselect_b64 s[72:73], s[18:19], s[64:65]
    s_cselect_b64 s[74:75], s[64:65], s[18:19]
    s_cmp_eq_u32 s31, 1
    s_cselect_b64 s[8:9], s[10:11], s[8:9]
    s_cselect_b64 s[64:65], s[18:19], s[64:65]
    s_mov_b32 s40, s8
    s_mov_b32 s41, s9
    s_mov_b32 s42, 65536
    s_mov_b32 s43, 0x00020000
    s_mov_b32 s8, s4
    s_mov_b32 s9, s5
    s_mov_b32 s10, 4194304
    s_mov_b32 s11, 0x00020000
    s_mov_b32 s12, s6
    s_mov_b32 s13, s7
    s_mov_b32 s14, 2097152
    s_mov_b32 s15, 0x00020000
    s_mov_b32 s56, s66
    s_mov_b32 s57, s67
    s_mov_b32 s58, 2048
    s_mov_b32 s59, 0x00020000
    s_lshl_b32 s36, s20, 12
    s_lshl_b32 s35, s33, 16
    s_mov_b32 s71, s36
    s_add_u32 s32, s36, 0x28000
    s_and_b32 s23, s29, 3
    s_mov_b32 m0, s71
    s_lshl_b32 s48, s37, 7
    s_add_u32 s48, s48, s38
    buffer_load_dwordx4 v8, s[8:11], s48 offen lds
    buffer_load_dwordx4 v9, s[8:11], s48 offen offset:1024 lds
    buffer_load_dwordx4 v10, s[8:11], s48 offen offset:2048 lds
    buffer_load_dwordx4 v11, s[8:11], s48 offen offset:3072 lds
    s_add_u32 m0, s71, 0x4000
    s_lshl_b32 s49, s37, 17
    s_add_u32 s49, s49, s39
    buffer_load_dwordx4 v12, s[12:15], s49 offen lds
    buffer_load_dwordx4 v13, s[12:15], s49 offen offset:1024 lds
    buffer_load_dwordx4 v14, s[12:15], s49 offen offset:2048 lds
    buffer_load_dwordx4 v15, s[12:15], s49 offen offset:3072 lds
    s_add_u32 s37, s37, 1
    s_and_b32 s37, s37, 15
    s_add_u32 s71, s71, 0x8000
    s_cmp_eq_u32 s71, s32
    s_cselect_b32 s71, s36, s71
    s_add_u32 m0, s36, 0x20000
    s_bfe_u32 s48, s2, 0x40003
    s_lshl_b32 s48, s48, 12
    s_lshl_b32 s49, s20, 10
    s_add_u32 s48, s48, s49
    buffer_load_dwordx4 v28, s[40:43], s48 offen lds
    s_mov_b32 s16, s26
    s_mov_b32 s17, s27
    s_mov_b32 s18, 9437184
    s_mov_b32 s19, 0x00020000
    s_mov_b32 s52, s64
    s_mov_b32 s53, s65
    s_mov_b32 s54, 2097152
    s_mov_b32 s55, 0x00020000
    s_mov_b32 s60, s24
    s_mov_b32 s61, s25
    s_mov_b32 s62, 256
    s_mov_b32 s63, 0x00020000
    s_load_dwordx2 s[64:65], s[0:1], 88
    s_lshl_b32 s48, s28, 18
    s_add_u32 s44, s26, s48
    s_addc_u32 s45, s27, 0
    s_mov_b32 s46, 0x40000
    s_mov_b32 s47, 0x00020000
    s_lshr_b32 s22, s20, 1
    s_and_b32 s21, s20, 1
    s_bfe_u32 s68, s2, 0x40003
    s_lshl_b32 s68, s68, 2
    s_add_u32 s68, s68, s20
    s_lshl_b32 s68, s68, 15
    s_lshl_b32 s69, s28, 10
    s_add_u32 s68, s68, s69
    s_or_b32 s70, s28, s31
    s_or_b32 s70, s70, s21
    v_lshl_add_u32 v24, v4, 3, v2
    v_and_b32 v25, 15, v24
    v_xor_b32 v25, v25, v3
    v_lshlrev_b32 v25, 4, v25
    v_lshl_add_u32 v96, v24, 11, v25
    v_xor_b32 v97, 32, v96
    v_add_u32 v97, 3072, v97
    v_xor_b32 v98, 64, v96
    v_add_u32 v98, 6144, v98
    v_xor_b32 v99, 96, v96
    v_add_u32 v99, 9216, v99
    v_and_b32 v6, 15, v1
    v_lshrrev_b32 v7, 4, v1
    v_xor_b32 v24, v6, v7
    v_lshlrev_b32 v24, 4, v24
    v_lshl_add_u32 v24, v6, 9, v24
    s_lshl_b32 s48, s22, 13
    v_add_u32 v100, s48, v24
    v_xor_b32 v101, 64, v100
    v_xor_b32 v102, 128, v100
    v_xor_b32 v103, 192, v100
    v_bfe_u32 v24, v1, 2, 2
    v_lshl_add_u32 v24, v7, 3, v24
    v_lshlrev_b32 v24, 6, v24
    v_and_b32 v25, 3, v1
    v_lshl_add_u32 v24, v25, 3, v24
    s_lshl_b32 s48, s21, 5
    s_add_u32 s48, s48, 0x4000
    v_add_u32 v104, s48, v24
    v_bfe_u32 v24, v1, 1, 3
    v_xor_b32 v24, v24, v2
    v_lshlrev_b32 v24, 4, v24
    v_lshl_add_u32 v24, v3, 7, v24
    s_lshl_b32 s48, s22, 13
    v_add_u32 v16, s48, v24
    v_xor_b32 v17, 32, v16
    v_xor_b32 v18, 64, v16
    v_xor_b32 v19, 96, v16
    v_bfe_u32 v24, v1, 2, 2
    v_lshl_add_u32 v25, v2, 3, v24
    v_lshlrev_b32 v25, 8, v25
    s_lshl_b32 s48, s21, 1
    v_xor_b32 v24, s48, v24
    v_lshl_add_u32 v25, v24, 6, v25
    v_bfe_u32 v24, v1, 4, 1
    v_lshl_add_u32 v25, v24, 5, v25
    v_and_b32 v24, 3, v1
    v_lshl_add_u32 v25, v24, 3, v25
    v_add_u32 v20, 0x4000, v25
    v_xor_b32 v21, 64, v20
    v_mov_b64 v[224:225], 0
    v_mov_b64 v[226:227], 0
    v_mov_b64 v[228:229], 0
    v_mov_b64 v[230:231], 0
    v_mov_b64 v[32:33], 0
    v_mov_b64 v[34:35], 0
    v_mov_b64 v[36:37], 0
    v_mov_b64 v[38:39], 0
    v_mov_b64 v[40:41], 0
    v_mov_b64 v[42:43], 0
    v_mov_b64 v[44:45], 0
    v_mov_b64 v[46:47], 0
    v_mov_b64 v[48:49], 0
    v_mov_b64 v[50:51], 0
    v_mov_b64 v[52:53], 0
    v_mov_b64 v[54:55], 0
    v_mov_b64 v[56:57], 0
    v_mov_b64 v[58:59], 0
    v_mov_b64 v[60:61], 0
    v_mov_b64 v[62:63], 0
    v_mov_b64 v[64:65], 0
    v_mov_b64 v[66:67], 0
    v_mov_b64 v[68:69], 0
    v_mov_b64 v[70:71], 0
    v_mov_b64 v[72:73], 0
    v_mov_b64 v[74:75], 0
    v_mov_b64 v[76:77], 0
    v_mov_b64 v[78:79], 0
    v_mov_b64 v[80:81], 0
    v_mov_b64 v[82:83], 0
    v_mov_b64 v[84:85], 0
    v_mov_b64 v[86:87], 0
    v_mov_b64 v[88:89], 0
    v_mov_b64 v[90:91], 0
    v_mov_b64 v[92:93], 0
    v_mov_b64 v[94:95], 0
    v_bfe_u32 v24, v6, 2, 1
    v_bfe_u32 v25, v6, 3, 1
    v_and_b32 v116, 3, v6
    v_lshl_add_u32 v116, v24, 3, v116
    v_lshl_add_u32 v116, v25, 2, v116
    s_cmp_eq_u32 s31, 1
    s_cselect_b64 vcc, -1, 0
    s_cselect_b32 s50, s21, s22
    s_cselect_b32 s51, s22, s21
    v_cndmask_b32 v116, v116, v6, vcc
    v_and_b32 v24, 1, v7
    v_lshl_add_u32 v116, v24, 5, v116
    v_lshlrev_b32 v116, 4, v116
    v_lshl_add_u32 v116, v2, 3, v116
    s_lshl_b32 s50, s50, 8
    s_lshl_b32 s51, s51, 10
    s_add_u32 s50, s50, s51
    s_lshl_b32 s51, s33, 12
    s_add_u32 s50, s50, s51
    s_lshl_b32 s51, s31, 11
    s_add_u32 s50, s50, s51
    v_add_u32 v116, s50, v116
    s_lshl_b32 s50, s33, 7
    s_lshl_b32 s51, s22, 6
    s_add_u32 s50, s50, s51
    s_add_u32 s50, s50, 524288
    s_cmp_eq_u32 s70, 0
    s_cselect_b32 s50, s50, 9437184
    v_lshl_add_u32 v117, v6, 2, s50
    v_lshl_add_u32 v117, v7, 24, v117
    s_lshl_b32 s69, s29, 7
    s_lshl_b32 s51, s28, 5
    s_add_u32 s69, s69, s51
    s_lshl_b32 s51, s30, 2
    s_add_u32 s69, s69, s51
    s_add_u32 s69, s69, 589824
    s_cmp_lg_u32 s20, 0
    s_cbranch_scc1 L_at_nofr
    v_mov_b32 v24, 0
    s_mov_b64 exec, 1
    buffer_atomic_swap v24, v24, s[16:19], s69 offen sc1
    s_mov_b64 exec, -1
L_at_nofr:
    s_mov_b32 s3, s34
    s_cmp_lg_u32 s70, 0
    s_cbranch_scc1 L_at_nogf
    v_and_b32 v24, 0x30, v1
    s_mov_b32 s50, s3
    s_mov_b32 exec_lo, 0x00010001
    s_mov_b32 exec_hi, 0x00010001
    s_lshl_b32 s51, s50, 9
    buffer_load_dwordx4 a[0:3], v24, s[56:59], s51 offen offset:0
    buffer_load_dwordx4 a[4:7], v24, s[56:59], s51 offen offset:64
    buffer_load_dwordx4 a[8:11], v24, s[56:59], s51 offen offset:128
    buffer_load_dwordx4 a[12:15], v24, s[56:59], s51 offen offset:192
    buffer_load_dwordx4 a[16:19], v24, s[56:59], s51 offen offset:256
    buffer_load_dwordx4 a[20:23], v24, s[56:59], s51 offen offset:320
    buffer_load_dwordx4 a[24:27], v24, s[56:59], s51 offen offset:384
    buffer_load_dwordx4 a[28:31], v24, s[56:59], s51 offen offset:448
    s_add_u32 s50, s50, 1
    s_and_b32 s50, s50, 3
    s_lshl_b32 s51, s50, 9
    buffer_load_dwordx4 a[32:35], v24, s[56:59], s51 offen offset:0
    buffer_load_dwordx4 a[36:39], v24, s[56:59], s51 offen offset:64
    buffer_load_dwordx4 a[40:43], v24, s[56:59], s51 offen offset:128
    buffer_load_dwordx4 a[44:47], v24, s[56:59], s51 offen offset:192
    buffer_load_dwordx4 a[48:51], v24, s[56:59], s51 offen offset:256
    buffer_load_dwordx4 a[52:55], v24, s[56:59], s51 offen offset:320
    buffer_load_dwordx4 a[56:59], v24, s[56:59], s51 offen offset:384
    buffer_load_dwordx4 a[60:63], v24, s[56:59], s51 offen offset:448
    s_add_u32 s50, s50, 1
    s_and_b32 s50, s50, 3
    s_lshl_b32 s51, s50, 9
    buffer_load_dwordx4 a[64:67], v24, s[56:59], s51 offen offset:0
    buffer_load_dwordx4 a[68:71], v24, s[56:59], s51 offen offset:64
    buffer_load_dwordx4 a[72:75], v24, s[56:59], s51 offen offset:128
    buffer_load_dwordx4 a[76:79], v24, s[56:59], s51 offen offset:192
    buffer_load_dwordx4 a[80:83], v24, s[56:59], s51 offen offset:256
    buffer_load_dwordx4 a[84:87], v24, s[56:59], s51 offen offset:320
    buffer_load_dwordx4 a[88:91], v24, s[56:59], s51 offen offset:384
    buffer_load_dwordx4 a[92:95], v24, s[56:59], s51 offen offset:448
    s_add_u32 s50, s50, 1
    s_and_b32 s50, s50, 3
    s_lshl_b32 s51, s50, 9
    buffer_load_dwordx4 a[96:99], v24, s[56:59], s51 offen offset:0
    buffer_load_dwordx4 a[100:103], v24, s[56:59], s51 offen offset:64
    buffer_load_dwordx4 a[104:107], v24, s[56:59], s51 offen offset:128
    buffer_load_dwordx4 a[108:111], v24, s[56:59], s51 offen offset:192
    buffer_load_dwordx4 a[112:115], v24, s[56:59], s51 offen offset:256
    buffer_load_dwordx4 a[116:119], v24, s[56:59], s51 offen offset:320
    buffer_load_dwordx4 a[120:123], v24, s[56:59], s51 offen offset:384
    buffer_load_dwordx4 a[124:127], v24, s[56:59], s51 offen offset:448
    s_add_u32 s50, s50, 1
    s_and_b32 s50, s50, 3
    s_mov_b64 exec, -1
L_at_nogf:
    s_mov_b32 m0, s71
    s_lshl_b32 s48, s37, 7
    s_add_u32 s48, s48, s38
    buffer_load_dwordx4 v8, s[8:11], s48 offen lds
    buffer_load_dwordx4 v9, s[8:11], s48 offen offset:1024 lds
    buffer_load_dwordx4 v10, s[8:11], s48 offen offset:2048 lds
    buffer_load_dwordx4 v11, s[8:11], s48 offen offset:3072 lds
    s_add_u32 m0, s71, 0x4000
    s_lshl_b32 s49, s37, 17
    s_add_u32 s49, s49, s39
    buffer_load_dwordx4 v12, s[12:15], s49 offen lds
    buffer_load_dwordx4 v13, s[12:15], s49 offen offset:1024 lds
    buffer_load_dwordx4 v14, s[12:15], s49 offen offset:2048 lds
    buffer_load_dwordx4 v15, s[12:15], s49 offen offset:3072 lds
    s_add_u32 s37, s37, 1
    s_and_b32 s37, s37, 15
    s_add_u32 s71, s71, 0x8000
    s_cmp_eq_u32 s71, s32
    s_cselect_b32 s71, s36, s71
    s_cmp_lg_u32 s20, s23
    s_cbranch_scc1 L_at_pro
    s_mov_b32 m0, s71
    s_lshl_b32 s48, s34, 9
    s_add_u32 s48, s48, s35
    buffer_load_dwordx4 v96, s[8:11], s48 offen lds
    buffer_load_dwordx4 v97, s[8:11], s48 offen offset:1024 lds
    buffer_load_dwordx4 v98, s[8:11], s48 offen offset:2048 lds
    buffer_load_dwordx4 v99, s[8:11], s48 offen offset:3072 lds
    s_add_u32 m0, s71, 0x4000
    s_lshl_b32 s49, s34, 14
    buffer_load_dwordx4 v29, s[40:43], s49 offen lds
    buffer_load_dwordx4 v29, s[40:43], s49 offen offset:1024 lds
    buffer_load_dwordx4 v29, s[40:43], s49 offen offset:2048 lds
    buffer_load_dwordx4 v29, s[40:43], s49 offen offset:3072 lds
    s_add_u32 s34, s34, 1
    s_and_b32 s34, s34, 3
    s_add_u32 s71, s71, 0x8000
    s_cmp_eq_u32 s71, s32
    s_cselect_b32 s71, s36, s71
    s_mov_b32 m0, s71
    s_lshl_b32 s48, s34, 9
    s_add_u32 s48, s48, s35
    buffer_load_dwordx4 v96, s[8:11], s48 offen lds
    buffer_load_dwordx4 v97, s[8:11], s48 offen offset:1024 lds
    buffer_load_dwordx4 v98, s[8:11], s48 offen offset:2048 lds
    buffer_load_dwordx4 v99, s[8:11], s48 offen offset:3072 lds
    s_add_u32 m0, s71, 0x4000
    s_lshl_b32 s49, s34, 14
    buffer_load_dwordx4 v29, s[40:43], s49 offen lds
    buffer_load_dwordx4 v29, s[40:43], s49 offen offset:1024 lds
    buffer_load_dwordx4 v29, s[40:43], s49 offen offset:2048 lds
    buffer_load_dwordx4 v29, s[40:43], s49 offen offset:3072 lds
    s_add_u32 s34, s34, 1
    s_and_b32 s34, s34, 3
    s_add_u32 s71, s71, 0x8000
    s_cmp_eq_u32 s71, s32
    s_cselect_b32 s71, s36, s71
L_at_pro:
    s_cmp_eq_u32 s20, s23
    s_waitcnt vmcnt(24) lgkmcnt(0)
    s_cbranch_scc1 L_at_w0
    s_waitcnt vmcnt(8)
L_at_w0:
    s_barrier
    s_mov_b32 m0, s71
    s_lshl_b32 s48, s34, 9
    s_add_u32 s48, s48, s35
    buffer_load_dwordx4 v96, s[8:11], s48 offen lds
    buffer_load_dwordx4 v97, s[8:11], s48 offen offset:1024 lds
    buffer_load_dwordx4 v98, s[8:11], s48 offen offset:2048 lds
    ds_read_b128 a[128:131], v16 offset:0
    ds_read_b64_tr_b16 a[136:137], v20 offset:0
    ds_read_b64_tr_b16 a[138:139], v20 offset:1024
    ds_read_b128 a[132:135], v16 offset:4096
    buffer_load_dwordx4 v99, s[8:11], s48 offen offset:3072 lds
    ds_read_b64_tr_b16 a[140:141], v21 offset:0
    ds_read_b64_tr_b16 a[142:143], v21 offset:1024
    ds_read_b128 a[144:147], v17 offset:0
    ds_read_b64_tr_b16 a[152:153], v20 offset:4096
    s_add_u32 m0, s71, 0x4000
    s_lshl_b32 s49, s34, 14
    buffer_load_dwordx4 v29, s[40:43], s49 offen lds
    ds_read_b64_tr_b16 a[154:155], v20 offset:5120
    ds_read_b128 a[148:151], v17 offset:4096
    ds_read_b64_tr_b16 a[156:157], v21 offset:4096
    ds_read_b64_tr_b16 a[158:159], v21 offset:5120
    buffer_load_dwordx4 v29, s[40:43], s49 offen offset:1024 lds
    ds_read_b128 a[160:163], v18 offset:0
    ds_read_b64_tr_b16 a[168:169], v20 offset:8192
    ds_read_b64_tr_b16 a[170:171], v20 offset:9216
    ds_read_b128 a[164:167], v18 offset:4096
    buffer_load_dwordx4 v29, s[40:43], s49 offen offset:2048 lds
    ds_read_b64_tr_b16 a[172:173], v21 offset:8192
    ds_read_b64_tr_b16 a[174:175], v21 offset:9216
    ds_read_b128 a[176:179], v19 offset:0
    ds_read_b64_tr_b16 a[184:185], v20 offset:12288
    buffer_load_dwordx4 v29, s[40:43], s49 offen offset:3072 lds
    ds_read_b64_tr_b16 a[186:187], v20 offset:13312
    ds_read_b128 a[180:183], v19 offset:4096
    ds_read_b64_tr_b16 a[188:189], v21 offset:12288
    ds_read_b64_tr_b16 a[190:191], v21 offset:13312
    s_add_u32 s34, s34, 1
    s_and_b32 s34, s34, 3
    s_add_u32 s71, s71, 0x8000
    s_cmp_eq_u32 s71, s32
    s_cselect_b32 s71, s36, s71
    s_cmp_eq_u32 s20, s23
    s_waitcnt vmcnt(24) lgkmcnt(0)
    s_cbranch_scc1 L_at_w1
    s_waitcnt vmcnt(8)
L_at_w1:
    s_barrier
    v_mfma_f32_32x32x16_bf16 v[32:47], a[136:139], a[128:131], v[32:47]
    ds_read_b128 a[192:195], v16 offset:32768
    ds_read_b64_tr_b16 a[200:201], v20 offset:32768
    s_mov_b32 m0, s71
    s_lshl_b32 s48, s34, 9
    s_add_u32 s48, s48, s35
    buffer_load_dwordx4 v96, s[8:11], s48 offen lds
    v_mfma_f32_32x32x16_bf16 v[48:63], a[136:139], a[132:135], v[48:63]
    ds_read_b64_tr_b16 a[202:203], v20 offset:33792
    ds_read_b128 a[196:199], v16 offset:36864
    v_mfma_f32_32x32x16_bf16 v[64:79], a[140:143], a[128:131], v[64:79]
    ds_read_b64_tr_b16 a[204:205], v21 offset:32768
    ds_read_b64_tr_b16 a[206:207], v21 offset:33792
    buffer_load_dwordx4 v97, s[8:11], s48 offen offset:1024 lds
    v_mfma_f32_32x32x16_bf16 v[80:95], a[140:143], a[132:135], v[80:95]
    ds_read_b128 a[208:211], v17 offset:32768
    ds_read_b64_tr_b16 a[216:217], v20 offset:36864
    v_mfma_f32_32x32x16_bf16 v[32:47], a[152:155], a[144:147], v[32:47]
    ds_read_b64_tr_b16 a[218:219], v20 offset:37888
    ds_read_b128 a[212:215], v17 offset:36864
    buffer_load_dwordx4 v98, s[8:11], s48 offen offset:2048 lds
    v_mfma_f32_32x32x16_bf16 v[48:63], a[152:155], a[148:151], v[48:63]
    ds_read_b64_tr_b16 a[220:221], v21 offset:36864
    ds_read_b64_tr_b16 a[222:223], v21 offset:37888
    v_mfma_f32_32x32x16_bf16 v[64:79], a[156:159], a[144:147], v[64:79]
    ds_read_b128 a[224:227], v18 offset:32768
    ds_read_b64_tr_b16 a[232:233], v20 offset:40960
    buffer_load_dwordx4 v99, s[8:11], s48 offen offset:3072 lds
    v_mfma_f32_32x32x16_bf16 v[80:95], a[156:159], a[148:151], v[80:95]
    ds_read_b64_tr_b16 a[234:235], v20 offset:41984
    ds_read_b128 a[228:231], v18 offset:36864
    v_mfma_f32_32x32x16_bf16 v[32:47], a[168:171], a[160:163], v[32:47]
    ds_read_b64_tr_b16 a[236:237], v21 offset:40960
    ds_read_b64_tr_b16 a[238:239], v21 offset:41984
    s_add_u32 m0, s71, 0x4000
    s_lshl_b32 s49, s34, 14
    buffer_load_dwordx4 v29, s[40:43], s49 offen lds
    v_mfma_f32_32x32x16_bf16 v[48:63], a[168:171], a[164:167], v[48:63]
    ds_read_b128 a[240:243], v19 offset:32768
    ds_read_b64_tr_b16 a[248:249], v20 offset:45056
    v_mfma_f32_32x32x16_bf16 v[64:79], a[172:175], a[160:163], v[64:79]
    ds_read_b64_tr_b16 a[250:251], v20 offset:46080
    ds_read_b128 a[244:247], v19 offset:36864
    buffer_load_dwordx4 v29, s[40:43], s49 offen offset:1024 lds
    v_mfma_f32_32x32x16_bf16 v[80:95], a[172:175], a[164:167], v[80:95]
    ds_read_b64_tr_b16 a[252:253], v21 offset:45056
    ds_read_b64_tr_b16 a[254:255], v21 offset:46080
    v_mfma_f32_32x32x16_bf16 v[32:47], a[184:187], a[176:179], v[32:47]
    buffer_load_dwordx4 v29, s[40:43], s49 offen offset:2048 lds
    v_add_u32 v100, 0x10000, v100
    v_add_u32 v101, 0x10000, v101
    v_mfma_f32_32x32x16_bf16 v[48:63], a[184:187], a[180:183], v[48:63]
    v_add_u32 v102, 0x10000, v102
    v_add_u32 v103, 0x10000, v103
    v_mfma_f32_32x32x16_bf16 v[64:79], a[188:191], a[176:179], v[64:79]
    buffer_load_dwordx4 v29, s[40:43], s49 offen offset:3072 lds
    v_add_u32 v104, 0x10000, v104
    v_mfma_f32_32x32x16_bf16 v[80:95], a[188:191], a[180:183], v[80:95]
    s_add_u32 s34, s34, 1
    s_and_b32 s34, s34, 3
    s_add_u32 s71, s71, 0x8000
    s_cmp_eq_u32 s71, s32
    s_cselect_b32 s71, s36, s71
    s_cmp_eq_u32 s20, s23
    s_waitcnt vmcnt(24) lgkmcnt(0)
    s_cbranch_scc1 L_at_w2
    s_waitcnt vmcnt(8)
L_at_w2:
    s_barrier
    s_cmp_eq_u32 s20, s23
    s_cbranch_scc1 L_at_ds2
    s_mov_b32 m0, s71
    s_lshl_b32 s48, s34, 9
    s_add_u32 s48, s48, s35
    buffer_load_dwordx4 v96, s[8:11], s48 offen lds
    ds_read_b128 v[160:163], v100 offset:0
    ds_read_b64_tr_b16 v[164:165], v104 offset:0
    ds_read_b64_tr_b16 v[166:167], v104 offset:256
    buffer_load_dwordx4 v97, s[8:11], s48 offen offset:1024 lds
    ds_read_b128 v[168:171], v101 offset:0
    ds_read_b64_tr_b16 v[172:173], v104 offset:2048
    ds_read_b64_tr_b16 v[174:175], v104 offset:2304
    buffer_load_dwordx4 v98, s[8:11], s48 offen offset:2048 lds
    ds_read_b128 v[176:179], v102 offset:0
    ds_read_b64_tr_b16 v[180:181], v104 offset:4096
    ds_read_b64_tr_b16 v[182:183], v104 offset:4352
    buffer_load_dwordx4 v99, s[8:11], s48 offen offset:3072 lds
    ds_read_b128 v[184:187], v103 offset:0
    ds_read_b64_tr_b16 v[188:189], v104 offset:6144
    ds_read_b64_tr_b16 v[190:191], v104 offset:6400
    s_add_u32 m0, s71, 0x4000
    s_lshl_b32 s49, s34, 14
    buffer_load_dwordx4 v29, s[40:43], s49 offen lds
    ds_read_b128 v[192:195], v100 offset:256
    ds_read_b64_tr_b16 v[196:197], v104 offset:8192
    ds_read_b64_tr_b16 v[198:199], v104 offset:8448
    buffer_load_dwordx4 v29, s[40:43], s49 offen offset:1024 lds
    ds_read_b128 v[200:203], v101 offset:256
    ds_read_b64_tr_b16 v[204:205], v104 offset:10240
    ds_read_b64_tr_b16 v[206:207], v104 offset:10496
    buffer_load_dwordx4 v29, s[40:43], s49 offen offset:2048 lds
    ds_read_b128 v[208:211], v102 offset:256
    ds_read_b64_tr_b16 v[212:213], v104 offset:12288
    ds_read_b64_tr_b16 v[214:215], v104 offset:12544
    buffer_load_dwordx4 v29, s[40:43], s49 offen offset:3072 lds
    ds_read_b128 v[216:219], v103 offset:256
    ds_read_b64_tr_b16 v[220:221], v104 offset:14336
    ds_read_b64_tr_b16 v[222:223], v104 offset:14592
    s_add_u32 s34, s34, 1
    s_and_b32 s34, s34, 3
    s_add_u32 s71, s71, 0x8000
    s_cmp_eq_u32 s71, s32
    s_cselect_b32 s71, s36, s71
    s_branch L_at_dj2
L_at_ds2:
    s_mov_b32 m0, s71
    s_lshl_b32 s48, s37, 7
    s_add_u32 s48, s48, s38
    buffer_load_dwordx4 v8, s[8:11], s48 offen lds
    ds_read_b128 v[160:163], v100 offset:0
    ds_read_b64_tr_b16 v[164:165], v104 offset:0
    ds_read_b64_tr_b16 v[166:167], v104 offset:256
    buffer_load_dwordx4 v9, s[8:11], s48 offen offset:1024 lds
    ds_read_b128 v[168:171], v101 offset:0
    ds_read_b64_tr_b16 v[172:173], v104 offset:2048
    ds_read_b64_tr_b16 v[174:175], v104 offset:2304
    buffer_load_dwordx4 v10, s[8:11], s48 offen offset:2048 lds
    ds_read_b128 v[176:179], v102 offset:0
    ds_read_b64_tr_b16 v[180:181], v104 offset:4096
    ds_read_b64_tr_b16 v[182:183], v104 offset:4352
    buffer_load_dwordx4 v11, s[8:11], s48 offen offset:3072 lds
    ds_read_b128 v[184:187], v103 offset:0
    ds_read_b64_tr_b16 v[188:189], v104 offset:6144
    ds_read_b64_tr_b16 v[190:191], v104 offset:6400
    s_add_u32 m0, s71, 0x4000
    s_lshl_b32 s49, s37, 17
    s_add_u32 s49, s49, s39
    buffer_load_dwordx4 v12, s[12:15], s49 offen lds
    ds_read_b128 v[192:195], v100 offset:256
    ds_read_b64_tr_b16 v[196:197], v104 offset:8192
    ds_read_b64_tr_b16 v[198:199], v104 offset:8448
    buffer_load_dwordx4 v13, s[12:15], s49 offen offset:1024 lds
    ds_read_b128 v[200:203], v101 offset:256
    ds_read_b64_tr_b16 v[204:205], v104 offset:10240
    ds_read_b64_tr_b16 v[206:207], v104 offset:10496
    buffer_load_dwordx4 v14, s[12:15], s49 offen offset:2048 lds
    ds_read_b128 v[208:211], v102 offset:256
    ds_read_b64_tr_b16 v[212:213], v104 offset:12288
    ds_read_b64_tr_b16 v[214:215], v104 offset:12544
    buffer_load_dwordx4 v15, s[12:15], s49 offen offset:3072 lds
    ds_read_b128 v[216:219], v103 offset:256
    ds_read_b64_tr_b16 v[220:221], v104 offset:14336
    ds_read_b64_tr_b16 v[222:223], v104 offset:14592
    s_add_u32 s37, s37, 1
    s_and_b32 s37, s37, 15
    s_add_u32 s71, s71, 0x8000
    s_cmp_eq_u32 s71, s32
    s_cselect_b32 s71, s36, s71
L_at_dj2:
    s_cmp_eq_u32 s20, s23
    s_waitcnt vmcnt(24) lgkmcnt(0)
    s_cbranch_scc1 L_at_w3
    s_waitcnt vmcnt(8)
L_at_w3:
    s_barrier
    s_cmp_eq_u32 s31, 1
    s_cbranch_scc1 L_at_pv2
    v_mfma_f32_16x16x32_bf16 v[224:227], v[164:167], v[160:163], v[224:227]
    v_mfma_f32_16x16x32_bf16 v[224:227], v[172:175], v[168:171], v[224:227]
    v_mfma_f32_16x16x32_bf16 v[224:227], v[180:183], v[176:179], v[224:227]
    v_mfma_f32_16x16x32_bf16 v[224:227], v[188:191], v[184:187], v[224:227]
    v_mfma_f32_16x16x32_bf16 v[224:227], v[196:199], v[192:195], v[224:227]
    v_mfma_f32_16x16x32_bf16 v[224:227], v[204:207], v[200:203], v[224:227]
    v_mfma_f32_16x16x32_bf16 v[224:227], v[212:215], v[208:211], v[224:227]
    v_mfma_f32_16x16x32_bf16 v[224:227], v[220:223], v[216:219], v[224:227]
    s_cmp_lg_u32 s70, 0
    s_cbranch_scc1 L_at_pj2
    v_mfma_f32_16x16x32_bf16 v[228:231], a[0:3], v[160:163], v[228:231]
    v_mfma_f32_16x16x32_bf16 v[228:231], a[4:7], v[168:171], v[228:231]
    v_mfma_f32_16x16x32_bf16 v[228:231], a[8:11], v[176:179], v[228:231]
    v_mfma_f32_16x16x32_bf16 v[228:231], a[12:15], v[184:187], v[228:231]
    v_mfma_f32_16x16x32_bf16 v[228:231], a[16:19], v[192:195], v[228:231]
    v_mfma_f32_16x16x32_bf16 v[228:231], a[20:23], v[200:203], v[228:231]
    v_mfma_f32_16x16x32_bf16 v[228:231], a[24:27], v[208:211], v[228:231]
    v_mfma_f32_16x16x32_bf16 v[228:231], a[28:31], v[216:219], v[228:231]
    s_branch L_at_pj2
L_at_pv2:
    v_mfma_f32_16x16x32_bf16 v[224:227], v[160:163], v[164:167], v[224:227]
    v_mfma_f32_16x16x32_bf16 v[224:227], v[168:171], v[172:175], v[224:227]
    v_mfma_f32_16x16x32_bf16 v[224:227], v[176:179], v[180:183], v[224:227]
    v_mfma_f32_16x16x32_bf16 v[224:227], v[184:187], v[188:191], v[224:227]
    v_mfma_f32_16x16x32_bf16 v[224:227], v[192:195], v[196:199], v[224:227]
    v_mfma_f32_16x16x32_bf16 v[224:227], v[200:203], v[204:207], v[224:227]
    v_mfma_f32_16x16x32_bf16 v[224:227], v[208:211], v[212:215], v[224:227]
    v_mfma_f32_16x16x32_bf16 v[224:227], v[216:219], v[220:223], v[224:227]
L_at_pj2:
    s_cmp_eq_u32 s20, s23
    s_cbranch_scc1 L_at_ds3
    s_mov_b32 m0, s71
    s_lshl_b32 s48, s34, 9
    s_add_u32 s48, s48, s35
    buffer_load_dwordx4 v96, s[8:11], s48 offen lds
    ds_read_b128 v[160:163], v100 offset:32768
    ds_read_b64_tr_b16 v[164:165], v104 offset:32768
    ds_read_b64_tr_b16 v[166:167], v104 offset:33024
    buffer_load_dwordx4 v97, s[8:11], s48 offen offset:1024 lds
    ds_read_b128 v[168:171], v101 offset:32768
    ds_read_b64_tr_b16 v[172:173], v104 offset:34816
    ds_read_b64_tr_b16 v[174:175], v104 offset:35072
    buffer_load_dwordx4 v98, s[8:11], s48 offen offset:2048 lds
    ds_read_b128 v[176:179], v102 offset:32768
    ds_read_b64_tr_b16 v[180:181], v104 offset:36864
    ds_read_b64_tr_b16 v[182:183], v104 offset:37120
    buffer_load_dwordx4 v99, s[8:11], s48 offen offset:3072 lds
    ds_read_b128 v[184:187], v103 offset:32768
    ds_read_b64_tr_b16 v[188:189], v104 offset:38912
    ds_read_b64_tr_b16 v[190:191], v104 offset:39168
    s_add_u32 m0, s71, 0x4000
    s_lshl_b32 s49, s34, 14
    buffer_load_dwordx4 v29, s[40:43], s49 offen lds
    ds_read_b128 v[192:195], v100 offset:33024
    ds_read_b64_tr_b16 v[196:197], v104 offset:40960
    ds_read_b64_tr_b16 v[198:199], v104 offset:41216
    buffer_load_dwordx4 v29, s[40:43], s49 offen offset:1024 lds
    ds_read_b128 v[200:203], v101 offset:33024
    ds_read_b64_tr_b16 v[204:205], v104 offset:43008
    ds_read_b64_tr_b16 v[206:207], v104 offset:43264
    buffer_load_dwordx4 v29, s[40:43], s49 offen offset:2048 lds
    ds_read_b128 v[208:211], v102 offset:33024
    ds_read_b64_tr_b16 v[212:213], v104 offset:45056
    ds_read_b64_tr_b16 v[214:215], v104 offset:45312
    buffer_load_dwordx4 v29, s[40:43], s49 offen offset:3072 lds
    ds_read_b128 v[216:219], v103 offset:33024
    ds_read_b64_tr_b16 v[220:221], v104 offset:47104
    ds_read_b64_tr_b16 v[222:223], v104 offset:47360
    s_add_u32 s34, s34, 1
    s_and_b32 s34, s34, 3
    s_add_u32 s71, s71, 0x8000
    s_cmp_eq_u32 s71, s32
    s_cselect_b32 s71, s36, s71
    s_branch L_at_dj3
L_at_ds3:
    s_mov_b32 m0, s71
    s_lshl_b32 s48, s37, 7
    s_add_u32 s48, s48, s38
    buffer_load_dwordx4 v8, s[8:11], s48 offen lds
    ds_read_b128 v[160:163], v100 offset:32768
    ds_read_b64_tr_b16 v[164:165], v104 offset:32768
    ds_read_b64_tr_b16 v[166:167], v104 offset:33024
    buffer_load_dwordx4 v9, s[8:11], s48 offen offset:1024 lds
    ds_read_b128 v[168:171], v101 offset:32768
    ds_read_b64_tr_b16 v[172:173], v104 offset:34816
    ds_read_b64_tr_b16 v[174:175], v104 offset:35072
    buffer_load_dwordx4 v10, s[8:11], s48 offen offset:2048 lds
    ds_read_b128 v[176:179], v102 offset:32768
    ds_read_b64_tr_b16 v[180:181], v104 offset:36864
    ds_read_b64_tr_b16 v[182:183], v104 offset:37120
    buffer_load_dwordx4 v11, s[8:11], s48 offen offset:3072 lds
    ds_read_b128 v[184:187], v103 offset:32768
    ds_read_b64_tr_b16 v[188:189], v104 offset:38912
    ds_read_b64_tr_b16 v[190:191], v104 offset:39168
    s_add_u32 m0, s71, 0x4000
    s_lshl_b32 s49, s37, 17
    s_add_u32 s49, s49, s39
    buffer_load_dwordx4 v12, s[12:15], s49 offen lds
    ds_read_b128 v[192:195], v100 offset:33024
    ds_read_b64_tr_b16 v[196:197], v104 offset:40960
    ds_read_b64_tr_b16 v[198:199], v104 offset:41216
    buffer_load_dwordx4 v13, s[12:15], s49 offen offset:1024 lds
    ds_read_b128 v[200:203], v101 offset:33024
    ds_read_b64_tr_b16 v[204:205], v104 offset:43008
    ds_read_b64_tr_b16 v[206:207], v104 offset:43264
    buffer_load_dwordx4 v14, s[12:15], s49 offen offset:2048 lds
    ds_read_b128 v[208:211], v102 offset:33024
    ds_read_b64_tr_b16 v[212:213], v104 offset:45056
    ds_read_b64_tr_b16 v[214:215], v104 offset:45312
    buffer_load_dwordx4 v15, s[12:15], s49 offen offset:3072 lds
    ds_read_b128 v[216:219], v103 offset:33024
    ds_read_b64_tr_b16 v[220:221], v104 offset:47104
    ds_read_b64_tr_b16 v[222:223], v104 offset:47360
    s_add_u32 s37, s37, 1
    s_and_b32 s37, s37, 15
    s_add_u32 s71, s71, 0x8000
    s_cmp_eq_u32 s71, s32
    s_cselect_b32 s71, s36, s71
L_at_dj3:
    v_add_u32 v100, 0x10000, v100
    v_add_u32 v101, 0x10000, v101
    v_add_u32 v102, 0x10000, v102
    v_add_u32 v103, 0x10000, v103
    v_add_u32 v104, 0x10000, v104
    s_cmp_eq_u32 s20, s23
    s_waitcnt vmcnt(24) lgkmcnt(0)
    s_cbranch_scc1 L_at_w4
    s_waitcnt vmcnt(8)
L_at_w4:
    s_barrier
    s_mov_b32 m0, s71
    s_lshl_b32 s48, s37, 7
    s_add_u32 s48, s48, s38
    buffer_load_dwordx4 v8, s[8:11], s48 offen lds
    buffer_load_dwordx4 v9, s[8:11], s48 offen offset:1024 lds
    s_cmp_eq_u32 s31, 1
    s_cbranch_scc1 L_at_pv3
    v_mfma_f32_16x16x32_bf16 v[224:227], v[164:167], v[160:163], v[224:227]
    v_mfma_f32_16x16x32_bf16 v[224:227], v[172:175], v[168:171], v[224:227]
    v_mfma_f32_16x16x32_bf16 v[224:227], v[180:183], v[176:179], v[224:227]
    v_mfma_f32_16x16x32_bf16 v[224:227], v[188:191], v[184:187], v[224:227]
    v_mfma_f32_16x16x32_bf16 v[224:227], v[196:199], v[192:195], v[224:227]
    v_mfma_f32_16x16x32_bf16 v[224:227], v[204:207], v[200:203], v[224:227]
    v_mfma_f32_16x16x32_bf16 v[224:227], v[212:215], v[208:211], v[224:227]
    v_mfma_f32_16x16x32_bf16 v[224:227], v[220:223], v[216:219], v[224:227]
    s_cmp_lg_u32 s70, 0
    s_cbranch_scc1 L_at_pj3
    v_mfma_f32_16x16x32_bf16 v[228:231], a[32:35], v[160:163], v[228:231]
    v_mfma_f32_16x16x32_bf16 v[228:231], a[36:39], v[168:171], v[228:231]
    v_mfma_f32_16x16x32_bf16 v[228:231], a[40:43], v[176:179], v[228:231]
    v_mfma_f32_16x16x32_bf16 v[228:231], a[44:47], v[184:187], v[228:231]
    v_mfma_f32_16x16x32_bf16 v[228:231], a[48:51], v[192:195], v[228:231]
    v_mfma_f32_16x16x32_bf16 v[228:231], a[52:55], v[200:203], v[228:231]
    v_mfma_f32_16x16x32_bf16 v[228:231], a[56:59], v[208:211], v[228:231]
    v_mfma_f32_16x16x32_bf16 v[228:231], a[60:63], v[216:219], v[228:231]
    s_branch L_at_pj3
L_at_pv3:
    v_mfma_f32_16x16x32_bf16 v[224:227], v[160:163], v[164:167], v[224:227]
    v_mfma_f32_16x16x32_bf16 v[224:227], v[168:171], v[172:175], v[224:227]
    v_mfma_f32_16x16x32_bf16 v[224:227], v[176:179], v[180:183], v[224:227]
    v_mfma_f32_16x16x32_bf16 v[224:227], v[184:187], v[188:191], v[224:227]
    v_mfma_f32_16x16x32_bf16 v[224:227], v[192:195], v[196:199], v[224:227]
    v_mfma_f32_16x16x32_bf16 v[224:227], v[200:203], v[204:207], v[224:227]
    v_mfma_f32_16x16x32_bf16 v[224:227], v[208:211], v[212:215], v[224:227]
    v_mfma_f32_16x16x32_bf16 v[224:227], v[216:219], v[220:223], v[224:227]
L_at_pj3:
    buffer_load_dwordx4 v10, s[8:11], s48 offen offset:2048 lds
    ds_read_b128 v[160:163], v100 offset:0
    ds_read_b64_tr_b16 v[164:165], v104 offset:0
    ds_read_b64_tr_b16 v[166:167], v104 offset:256
    ds_read_b128 v[168:171], v101 offset:0
    buffer_load_dwordx4 v11, s[8:11], s48 offen offset:3072 lds
    ds_read_b64_tr_b16 v[172:173], v104 offset:2048
    ds_read_b64_tr_b16 v[174:175], v104 offset:2304
    ds_read_b128 v[176:179], v102 offset:0
    ds_read_b64_tr_b16 v[180:181], v104 offset:4096
    s_add_u32 m0, s71, 0x4000
    s_lshl_b32 s49, s37, 17
    s_add_u32 s49, s49, s39
    buffer_load_dwordx4 v12, s[12:15], s49 offen lds
    ds_read_b64_tr_b16 v[182:183], v104 offset:4352
    ds_read_b128 v[184:187], v103 offset:0
    ds_read_b64_tr_b16 v[188:189], v104 offset:6144
    ds_read_b64_tr_b16 v[190:191], v104 offset:6400
    buffer_load_dwordx4 v13, s[12:15], s49 offen offset:1024 lds
    ds_read_b128 v[192:195], v100 offset:256
    ds_read_b64_tr_b16 v[196:197], v104 offset:8192
    ds_read_b64_tr_b16 v[198:199], v104 offset:8448
    ds_read_b128 v[200:203], v101 offset:256
    buffer_load_dwordx4 v14, s[12:15], s49 offen offset:2048 lds
    ds_read_b64_tr_b16 v[204:205], v104 offset:10240
    ds_read_b64_tr_b16 v[206:207], v104 offset:10496
    ds_read_b128 v[208:211], v102 offset:256
    ds_read_b64_tr_b16 v[212:213], v104 offset:12288
    buffer_load_dwordx4 v15, s[12:15], s49 offen offset:3072 lds
    ds_read_b64_tr_b16 v[214:215], v104 offset:12544
    ds_read_b128 v[216:219], v103 offset:256
    ds_read_b64_tr_b16 v[220:221], v104 offset:14336
    ds_read_b64_tr_b16 v[222:223], v104 offset:14592
    s_add_u32 s37, s37, 1
    s_and_b32 s37, s37, 15
    s_add_u32 s71, s71, 0x8000
    s_cmp_eq_u32 s71, s32
    s_cselect_b32 s71, s36, s71
    v_add_u32 v100, 0xfffe0000, v100
    v_add_u32 v101, 0xfffe0000, v101
    v_add_u32 v102, 0xfffe0000, v102
    v_add_u32 v103, 0xfffe0000, v103
    v_add_u32 v104, 0xfffe0000, v104
    s_cmp_eq_u32 s20, s23
    s_waitcnt vmcnt(24) lgkmcnt(0)
    s_cbranch_scc1 L_at_w5
    s_waitcnt vmcnt(8)
L_at_w5:
    s_barrier
    s_mov_b32 m0, s71
    s_lshl_b32 s48, s37, 7
    s_add_u32 s48, s48, s38
    buffer_load_dwordx4 v8, s[8:11], s48 offen lds
    buffer_load_dwordx4 v9, s[8:11], s48 offen offset:1024 lds
    s_cmp_eq_u32 s31, 1
    s_cbranch_scc1 L_at_pv4
    v_mfma_f32_16x16x32_bf16 v[224:227], v[164:167], v[160:163], v[224:227]
    v_mfma_f32_16x16x32_bf16 v[224:227], v[172:175], v[168:171], v[224:227]
    v_mfma_f32_16x16x32_bf16 v[224:227], v[180:183], v[176:179], v[224:227]
    v_mfma_f32_16x16x32_bf16 v[224:227], v[188:191], v[184:187], v[224:227]
    v_mfma_f32_16x16x32_bf16 v[224:227], v[196:199], v[192:195], v[224:227]
    v_mfma_f32_16x16x32_bf16 v[224:227], v[204:207], v[200:203], v[224:227]
    v_mfma_f32_16x16x32_bf16 v[224:227], v[212:215], v[208:211], v[224:227]
    v_mfma_f32_16x16x32_bf16 v[224:227], v[220:223], v[216:219], v[224:227]
    s_cmp_lg_u32 s70, 0
    s_cbranch_scc1 L_at_pj4
    v_mfma_f32_16x16x32_bf16 v[228:231], a[64:67], v[160:163], v[228:231]
    v_mfma_f32_16x16x32_bf16 v[228:231], a[68:71], v[168:171], v[228:231]
    v_mfma_f32_16x16x32_bf16 v[228:231], a[72:75], v[176:179], v[228:231]
    v_mfma_f32_16x16x32_bf16 v[228:231], a[76:79], v[184:187], v[228:231]
    v_mfma_f32_16x16x32_bf16 v[228:231], a[80:83], v[192:195], v[228:231]
    v_mfma_f32_16x16x32_bf16 v[228:231], a[84:87], v[200:203], v[228:231]
    v_mfma_f32_16x16x32_bf16 v[228:231], a[88:91], v[208:211], v[228:231]
    v_mfma_f32_16x16x32_bf16 v[228:231], a[92:95], v[216:219], v[228:231]
    s_branch L_at_pj4
L_at_pv4:
    v_mfma_f32_16x16x32_bf16 v[224:227], v[160:163], v[164:167], v[224:227]
    v_mfma_f32_16x16x32_bf16 v[224:227], v[168:171], v[172:175], v[224:227]
    v_mfma_f32_16x16x32_bf16 v[224:227], v[176:179], v[180:183], v[224:227]
    v_mfma_f32_16x16x32_bf16 v[224:227], v[184:187], v[188:191], v[224:227]
    v_mfma_f32_16x16x32_bf16 v[224:227], v[192:195], v[196:199], v[224:227]
    v_mfma_f32_16x16x32_bf16 v[224:227], v[200:203], v[204:207], v[224:227]
    v_mfma_f32_16x16x32_bf16 v[224:227], v[208:211], v[212:215], v[224:227]
    v_mfma_f32_16x16x32_bf16 v[224:227], v[216:219], v[220:223], v[224:227]
L_at_pj4:
    buffer_load_dwordx4 v10, s[8:11], s48 offen offset:2048 lds
    ds_read_b128 v[160:163], v100 offset:0
    ds_read_b64_tr_b16 v[164:165], v104 offset:0
    ds_read_b64_tr_b16 v[166:167], v104 offset:256
    ds_read_b128 v[168:171], v101 offset:0
    buffer_load_dwordx4 v11, s[8:11], s48 offen offset:3072 lds
    ds_read_b64_tr_b16 v[172:173], v104 offset:2048
    ds_read_b64_tr_b16 v[174:175], v104 offset:2304
    ds_read_b128 v[176:179], v102 offset:0
    ds_read_b64_tr_b16 v[180:181], v104 offset:4096
    s_add_u32 m0, s71, 0x4000
    s_lshl_b32 s49, s37, 17
    s_add_u32 s49, s49, s39
    buffer_load_dwordx4 v12, s[12:15], s49 offen lds
    ds_read_b64_tr_b16 v[182:183], v104 offset:4352
    ds_read_b128 v[184:187], v103 offset:0
    ds_read_b64_tr_b16 v[188:189], v104 offset:6144
    ds_read_b64_tr_b16 v[190:191], v104 offset:6400
    buffer_load_dwordx4 v13, s[12:15], s49 offen offset:1024 lds
    ds_read_b128 v[192:195], v100 offset:256
    ds_read_b64_tr_b16 v[196:197], v104 offset:8192
    ds_read_b64_tr_b16 v[198:199], v104 offset:8448
    ds_read_b128 v[200:203], v101 offset:256
    buffer_load_dwordx4 v14, s[12:15], s49 offen offset:2048 lds
    ds_read_b64_tr_b16 v[204:205], v104 offset:10240
    ds_read_b64_tr_b16 v[206:207], v104 offset:10496
    ds_read_b128 v[208:211], v102 offset:256
    ds_read_b64_tr_b16 v[212:213], v104 offset:12288
    buffer_load_dwordx4 v15, s[12:15], s49 offen offset:3072 lds
    ds_read_b64_tr_b16 v[214:215], v104 offset:12544
    ds_read_b128 v[216:219], v103 offset:256
    ds_read_b64_tr_b16 v[220:221], v104 offset:14336
    ds_read_b64_tr_b16 v[222:223], v104 offset:14592
    s_add_u32 s37, s37, 1
    s_and_b32 s37, s37, 15
    s_add_u32 s71, s71, 0x8000
    s_cmp_eq_u32 s71, s32
    s_cselect_b32 s71, s36, s71
    s_cmp_eq_u32 s20, s23
    s_waitcnt vmcnt(24) lgkmcnt(0)
    s_cbranch_scc1 L_at_w6
    s_waitcnt vmcnt(8)
L_at_w6:
    s_barrier
    s_cmp_eq_u32 s31, 1
    s_cbranch_scc1 L_at_pv5
    v_mfma_f32_16x16x32_bf16 v[224:227], v[164:167], v[160:163], v[224:227]
    v_mfma_f32_16x16x32_bf16 v[224:227], v[172:175], v[168:171], v[224:227]
    v_mfma_f32_16x16x32_bf16 v[224:227], v[180:183], v[176:179], v[224:227]
    v_mfma_f32_16x16x32_bf16 v[224:227], v[188:191], v[184:187], v[224:227]
    v_mfma_f32_16x16x32_bf16 v[224:227], v[196:199], v[192:195], v[224:227]
    v_mfma_f32_16x16x32_bf16 v[224:227], v[204:207], v[200:203], v[224:227]
    v_mfma_f32_16x16x32_bf16 v[224:227], v[212:215], v[208:211], v[224:227]
    v_mfma_f32_16x16x32_bf16 v[224:227], v[220:223], v[216:219], v[224:227]
    s_cmp_lg_u32 s70, 0
    s_cbranch_scc1 L_at_pj5
    v_mfma_f32_16x16x32_bf16 v[228:231], a[96:99], v[160:163], v[228:231]
    v_mfma_f32_16x16x32_bf16 v[228:231], a[100:103], v[168:171], v[228:231]
    v_mfma_f32_16x16x32_bf16 v[228:231], a[104:107], v[176:179], v[228:231]
    v_mfma_f32_16x16x32_bf16 v[228:231], a[108:111], v[184:187], v[228:231]
    v_mfma_f32_16x16x32_bf16 v[228:231], a[112:115], v[192:195], v[228:231]
    v_mfma_f32_16x16x32_bf16 v[228:231], a[116:119], v[200:203], v[228:231]
    v_mfma_f32_16x16x32_bf16 v[228:231], a[120:123], v[208:211], v[228:231]
    v_mfma_f32_16x16x32_bf16 v[228:231], a[124:127], v[216:219], v[228:231]
    s_branch L_at_pj5
L_at_pv5:
    v_mfma_f32_16x16x32_bf16 v[224:227], v[160:163], v[164:167], v[224:227]
    v_mfma_f32_16x16x32_bf16 v[224:227], v[168:171], v[172:175], v[224:227]
    v_mfma_f32_16x16x32_bf16 v[224:227], v[176:179], v[180:183], v[224:227]
    v_mfma_f32_16x16x32_bf16 v[224:227], v[184:187], v[188:191], v[224:227]
    v_mfma_f32_16x16x32_bf16 v[224:227], v[192:195], v[196:199], v[224:227]
    v_mfma_f32_16x16x32_bf16 v[224:227], v[200:203], v[204:207], v[224:227]
    v_mfma_f32_16x16x32_bf16 v[224:227], v[208:211], v[212:215], v[224:227]
    v_mfma_f32_16x16x32_bf16 v[224:227], v[216:219], v[220:223], v[224:227]
L_at_pj5:
    v_mfma_f32_32x32x16_bf16 v[32:47], a[200:203], a[192:195], v[32:47]
    ds_read_b128 a[128:131], v16 offset:32768
    ds_read_b64_tr_b16 a[136:137], v20 offset:32768
    s_mov_b32 m0, s71
    s_lshl_b32 s48, s37, 7
    s_add_u32 s48, s48, s38
    buffer_load_dwordx4 v8, s[8:11], s48 offen lds
    s_nop 0
    v_mfma_f32_32x32x16_bf16 v[48:63], a[200:203], a[196:199], v[48:63]
    ds_read_b64_tr_b16 a[138:139], v20 offset:33792
    ds_read_b128 a[132:135], v16 offset:36864
    s_nop 0
    v_mfma_f32_32x32x16_bf16 v[64:79], a[204:207], a[192:195], v[64:79]
    ds_read_b64_tr_b16 a[140:141], v21 offset:32768
    ds_read_b64_tr_b16 a[142:143], v21 offset:33792
    buffer_load_dwordx4 v9, s[8:11], s48 offen offset:1024 lds
    s_mov_b32 s50, 1.0
    s_cmp_eq_u32 s31, 1
    s_cselect_b32 s50, s50, 0x3e8293ee
    v_mfma_f32_32x32x16_bf16 v[80:95], a[204:207], a[196:199], v[80:95]
    ds_read_b128 a[144:147], v17 offset:32768
    ds_read_b64_tr_b16 a[152:153], v20 offset:36864
    v_mul_f32 v224, s50, v224
    v_mul_f32 v225, s50, v225
    v_mul_f32 v226, s50, v226
    v_mul_f32 v227, s50, v227
    v_mfma_f32_32x32x16_bf16 v[32:47], a[216:219], a[208:211], v[32:47]
    ds_read_b64_tr_b16 a[154:155], v20 offset:37888
    ds_read_b128 a[148:151], v17 offset:36864
    buffer_load_dwordx4 v10, s[8:11], s48 offen offset:2048 lds
    v_cvt_pk_bf16_f32 v232, v224, v225
    v_cvt_pk_bf16_f32 v233, v226, v227
    v_mfma_f32_32x32x16_bf16 v[48:63], a[216:219], a[212:215], v[48:63]
    ds_read_b64_tr_b16 a[156:157], v21 offset:36864
    ds_read_b64_tr_b16 a[158:159], v21 offset:37888
    v_mul_f32 v228, 0xbfb8aa3b, v228
    v_exp_f32 v228, v228
    v_mfma_f32_32x32x16_bf16 v[64:79], a[220:223], a[208:211], v[64:79]
    ds_read_b128 a[160:163], v18 offset:32768
    ds_read_b64_tr_b16 a[168:169], v20 offset:40960
    buffer_load_dwordx4 v11, s[8:11], s48 offen offset:3072 lds
    v_add_f32 v228, 1.0, v228
    v_rcp_f32 v228, v228
    v_mfma_f32_32x32x16_bf16 v[80:95], a[220:223], a[212:215], v[80:95]
    ds_read_b64_tr_b16 a[170:171], v20 offset:41984
    ds_read_b128 a[164:167], v18 offset:36864
    v_mfma_f32_32x32x16_bf16 v[32:47], a[232:235], a[224:227], v[32:47]
    ds_read_b64_tr_b16 a[172:173], v21 offset:40960
    ds_read_b64_tr_b16 a[174:175], v21 offset:41984
    s_add_u32 m0, s71, 0x4000
    s_lshl_b32 s49, s37, 17
    s_add_u32 s49, s49, s39
    buffer_load_dwordx4 v12, s[12:15], s49 offen lds
    v_mfma_f32_32x32x16_bf16 v[48:63], a[232:235], a[228:231], v[48:63]
    ds_read_b128 a[176:179], v19 offset:32768
    ds_read_b64_tr_b16 a[184:185], v20 offset:45056
    v_mfma_f32_32x32x16_bf16 v[64:79], a[236:239], a[224:227], v[64:79]
    ds_read_b64_tr_b16 a[186:187], v20 offset:46080
    ds_read_b128 a[180:183], v19 offset:36864
    buffer_load_dwordx4 v13, s[12:15], s49 offen offset:1024 lds
    v_mfma_f32_32x32x16_bf16 v[80:95], a[236:239], a[228:231], v[80:95]
    ds_read_b64_tr_b16 a[188:189], v21 offset:45056
    ds_read_b64_tr_b16 a[190:191], v21 offset:46080
    v_mfma_f32_32x32x16_bf16 v[32:47], a[248:251], a[240:243], v[32:47]
    buffer_load_dwordx4 v14, s[12:15], s49 offen offset:2048 lds
    v_add_u32 v16, 0x10000, v16
    v_add_u32 v17, 0x10000, v17
    v_mfma_f32_32x32x16_bf16 v[48:63], a[248:251], a[244:247], v[48:63]
    v_add_u32 v18, 0x10000, v18
    v_add_u32 v19, 0x10000, v19
    v_mfma_f32_32x32x16_bf16 v[64:79], a[252:255], a[240:243], v[64:79]
    buffer_load_dwordx4 v15, s[12:15], s49 offen offset:3072 lds
    v_add_u32 v20, 0x10000, v20
    v_add_u32 v21, 0x10000, v21
    v_mfma_f32_32x32x16_bf16 v[80:95], a[252:255], a[244:247], v[80:95]
    s_add_u32 s37, s37, 1
    s_and_b32 s37, s37, 15
    s_add_u32 s71, s71, 0x8000
    s_cmp_eq_u32 s71, s32
    s_cselect_b32 s71, s36, s71
    buffer_store_dwordx2 v[232:233], v116, s[44:47], 0 offen sc1
    buffer_store_dword v228, v117, s[16:19], 0 offen sc1
    s_cmp_eq_u32 s20, s23
    s_waitcnt vmcnt(24) lgkmcnt(0)
    s_cbranch_scc1 L_at_w7
    s_waitcnt vmcnt(10)
L_at_w7:
    s_barrier
    v_mfma_f32_32x32x16_bf16 v[32:47], a[136:139], a[128:131], v[32:47]
    ds_read_b128 a[192:195], v16 offset:0
    ds_read_b64_tr_b16 a[200:201], v20 offset:0
    s_mov_b32 m0, s71
    s_lshl_b32 s48, s37, 7
    s_add_u32 s48, s48, s38
    buffer_load_dwordx4 v8, s[8:11], s48 offen lds
    v_mfma_f32_32x32x16_bf16 v[48:63], a[136:139], a[132:135], v[48:63]
    ds_read_b64_tr_b16 a[202:203], v20 offset:1024
    ds_read_b128 a[196:199], v16 offset:4096
    v_mfma_f32_32x32x16_bf16 v[64:79], a[140:143], a[128:131], v[64:79]
    ds_read_b64_tr_b16 a[204:205], v21 offset:0
    ds_read_b64_tr_b16 a[206:207], v21 offset:1024
    buffer_load_dwordx4 v9, s[8:11], s48 offen offset:1024 lds
    v_mfma_f32_32x32x16_bf16 v[80:95], a[140:143], a[132:135], v[80:95]
    ds_read_b128 a[208:211], v17 offset:0
    ds_read_b64_tr_b16 a[216:217], v20 offset:4096
    v_mfma_f32_32x32x16_bf16 v[32:47], a[152:155], a[144:147], v[32:47]
    ds_read_b64_tr_b16 a[218:219], v20 offset:5120
    ds_read_b128 a[212:215], v17 offset:4096
    buffer_load_dwordx4 v10, s[8:11], s48 offen offset:2048 lds
    v_mfma_f32_32x32x16_bf16 v[48:63], a[152:155], a[148:151], v[48:63]
    ds_read_b64_tr_b16 a[220:221], v21 offset:4096
    ds_read_b64_tr_b16 a[222:223], v21 offset:5120
    v_mfma_f32_32x32x16_bf16 v[64:79], a[156:159], a[144:147], v[64:79]
    ds_read_b128 a[224:227], v18 offset:0
    ds_read_b64_tr_b16 a[232:233], v20 offset:8192
    buffer_load_dwordx4 v11, s[8:11], s48 offen offset:3072 lds
    v_mfma_f32_32x32x16_bf16 v[80:95], a[156:159], a[148:151], v[80:95]
    ds_read_b64_tr_b16 a[234:235], v20 offset:9216
    ds_read_b128 a[228:231], v18 offset:4096
    v_mfma_f32_32x32x16_bf16 v[32:47], a[168:171], a[160:163], v[32:47]
    ds_read_b64_tr_b16 a[236:237], v21 offset:8192
    ds_read_b64_tr_b16 a[238:239], v21 offset:9216
    s_add_u32 m0, s71, 0x4000
    s_lshl_b32 s49, s37, 17
    s_add_u32 s49, s49, s39
    buffer_load_dwordx4 v12, s[12:15], s49 offen lds
    v_mfma_f32_32x32x16_bf16 v[48:63], a[168:171], a[164:167], v[48:63]
    ds_read_b128 a[240:243], v19 offset:0
    ds_read_b64_tr_b16 a[248:249], v20 offset:12288
    v_mfma_f32_32x32x16_bf16 v[64:79], a[172:175], a[160:163], v[64:79]
    ds_read_b64_tr_b16 a[250:251], v20 offset:13312
    ds_read_b128 a[244:247], v19 offset:4096
    buffer_load_dwordx4 v13, s[12:15], s49 offen offset:1024 lds
    v_mfma_f32_32x32x16_bf16 v[80:95], a[172:175], a[164:167], v[80:95]
    ds_read_b64_tr_b16 a[252:253], v21 offset:12288
    ds_read_b64_tr_b16 a[254:255], v21 offset:13312
    v_mfma_f32_32x32x16_bf16 v[32:47], a[184:187], a[176:179], v[32:47]
    buffer_load_dwordx4 v14, s[12:15], s49 offen offset:2048 lds
    v_mfma_f32_32x32x16_bf16 v[48:63], a[184:187], a[180:183], v[48:63]
    v_mfma_f32_32x32x16_bf16 v[64:79], a[188:191], a[176:179], v[64:79]
    buffer_load_dwordx4 v15, s[12:15], s49 offen offset:3072 lds
    v_mfma_f32_32x32x16_bf16 v[80:95], a[188:191], a[180:183], v[80:95]
    s_add_u32 s37, s37, 1
    s_and_b32 s37, s37, 15
    s_add_u32 s71, s71, 0x8000
    s_cmp_eq_u32 s71, s32
    s_cselect_b32 s71, s36, s71
    s_cmp_eq_u32 s20, s23
    s_waitcnt vmcnt(24) lgkmcnt(0)
    s_cbranch_scc1 L_at_w8
    s_waitcnt vmcnt(10)
L_at_w8:
    s_barrier
    v_mfma_f32_32x32x16_bf16 v[32:47], a[200:203], a[192:195], v[32:47]
    ds_read_b128 a[128:131], v16 offset:32768
    ds_read_b64_tr_b16 a[136:137], v20 offset:32768
    s_mov_b32 m0, s71
    s_lshl_b32 s48, s37, 7
    s_add_u32 s48, s48, s38
    buffer_load_dwordx4 v8, s[8:11], s48 offen lds
    v_mfma_f32_32x32x16_bf16 v[48:63], a[200:203], a[196:199], v[48:63]
    ds_read_b64_tr_b16 a[138:139], v20 offset:33792
    ds_read_b128 a[132:135], v16 offset:36864
    v_mfma_f32_32x32x16_bf16 v[64:79], a[204:207], a[192:195], v[64:79]
    ds_read_b64_tr_b16 a[140:141], v21 offset:32768
    ds_read_b64_tr_b16 a[142:143], v21 offset:33792
    buffer_load_dwordx4 v9, s[8:11], s48 offen offset:1024 lds
    v_mfma_f32_32x32x16_bf16 v[80:95], a[204:207], a[196:199], v[80:95]
    ds_read_b128 a[144:147], v17 offset:32768
    ds_read_b64_tr_b16 a[152:153], v20 offset:36864
    v_mfma_f32_32x32x16_bf16 v[32:47], a[216:219], a[208:211], v[32:47]
    ds_read_b64_tr_b16 a[154:155], v20 offset:37888
    ds_read_b128 a[148:151], v17 offset:36864
    buffer_load_dwordx4 v10, s[8:11], s48 offen offset:2048 lds
    v_mfma_f32_32x32x16_bf16 v[48:63], a[216:219], a[212:215], v[48:63]
    ds_read_b64_tr_b16 a[156:157], v21 offset:36864
    ds_read_b64_tr_b16 a[158:159], v21 offset:37888
    v_mfma_f32_32x32x16_bf16 v[64:79], a[220:223], a[208:211], v[64:79]
    ds_read_b128 a[160:163], v18 offset:32768
    ds_read_b64_tr_b16 a[168:169], v20 offset:40960
    buffer_load_dwordx4 v11, s[8:11], s48 offen offset:3072 lds
    v_mfma_f32_32x32x16_bf16 v[80:95], a[220:223], a[212:215], v[80:95]
    ds_read_b64_tr_b16 a[170:171], v20 offset:41984
    ds_read_b128 a[164:167], v18 offset:36864
    v_mfma_f32_32x32x16_bf16 v[32:47], a[232:235], a[224:227], v[32:47]
    ds_read_b64_tr_b16 a[172:173], v21 offset:40960
    ds_read_b64_tr_b16 a[174:175], v21 offset:41984
    s_add_u32 m0, s71, 0x4000
    s_lshl_b32 s49, s37, 17
    s_add_u32 s49, s49, s39
    buffer_load_dwordx4 v12, s[12:15], s49 offen lds
    v_mfma_f32_32x32x16_bf16 v[48:63], a[232:235], a[228:231], v[48:63]
    ds_read_b128 a[176:179], v19 offset:32768
    ds_read_b64_tr_b16 a[184:185], v20 offset:45056
    v_mfma_f32_32x32x16_bf16 v[64:79], a[236:239], a[224:227], v[64:79]
    ds_read_b64_tr_b16 a[186:187], v20 offset:46080
    ds_read_b128 a[180:183], v19 offset:36864
    buffer_load_dwordx4 v13, s[12:15], s49 offen offset:1024 lds
    v_mfma_f32_32x32x16_bf16 v[80:95], a[236:239], a[228:231], v[80:95]
    ds_read_b64_tr_b16 a[188:189], v21 offset:45056
    ds_read_b64_tr_b16 a[190:191], v21 offset:46080
    v_mfma_f32_32x32x16_bf16 v[32:47], a[248:251], a[240:243], v[32:47]
    buffer_load_dwordx4 v14, s[12:15], s49 offen offset:2048 lds
    v_add_u32 v16, 0x10000, v16
    v_add_u32 v17, 0x10000, v17
    v_mfma_f32_32x32x16_bf16 v[48:63], a[248:251], a[244:247], v[48:63]
    v_add_u32 v18, 0x10000, v18
    v_add_u32 v19, 0x10000, v19
    v_mfma_f32_32x32x16_bf16 v[64:79], a[252:255], a[240:243], v[64:79]
    buffer_load_dwordx4 v15, s[12:15], s49 offen offset:3072 lds
    v_add_u32 v20, 0x10000, v20
    v_add_u32 v21, 0x10000, v21
    v_mfma_f32_32x32x16_bf16 v[80:95], a[252:255], a[244:247], v[80:95]
    s_add_u32 s37, s37, 1
    s_and_b32 s37, s37, 15
    s_add_u32 s71, s71, 0x8000
    s_cmp_eq_u32 s71, s32
    s_cselect_b32 s71, s36, s71
    s_cmp_eq_u32 s20, s23
    s_waitcnt vmcnt(16) lgkmcnt(0)
    s_cbranch_scc1 L_at_w9
    s_waitcnt vmcnt(8)
L_at_w9:
    s_barrier
    v_mfma_f32_32x32x16_bf16 v[32:47], a[136:139], a[128:131], v[32:47]
    ds_read_b128 a[192:195], v16 offset:0
    ds_read_b64_tr_b16 a[200:201], v20 offset:0
    s_mov_b32 m0, s71
    s_lshl_b32 s48, s37, 7
    s_add_u32 s48, s48, s38
    buffer_load_dwordx4 v8, s[8:11], s48 offen lds
    v_mfma_f32_32x32x16_bf16 v[48:63], a[136:139], a[132:135], v[48:63]
    ds_read_b64_tr_b16 a[202:203], v20 offset:1024
    ds_read_b128 a[196:199], v16 offset:4096
    v_mfma_f32_32x32x16_bf16 v[64:79], a[140:143], a[128:131], v[64:79]
    ds_read_b64_tr_b16 a[204:205], v21 offset:0
    ds_read_b64_tr_b16 a[206:207], v21 offset:1024
    buffer_load_dwordx4 v9, s[8:11], s48 offen offset:1024 lds
    v_mfma_f32_32x32x16_bf16 v[80:95], a[140:143], a[132:135], v[80:95]
    ds_read_b128 a[208:211], v17 offset:0
    ds_read_b64_tr_b16 a[216:217], v20 offset:4096
    v_mfma_f32_32x32x16_bf16 v[32:47], a[152:155], a[144:147], v[32:47]
    ds_read_b64_tr_b16 a[218:219], v20 offset:5120
    ds_read_b128 a[212:215], v17 offset:4096
    buffer_load_dwordx4 v10, s[8:11], s48 offen offset:2048 lds
    v_mfma_f32_32x32x16_bf16 v[48:63], a[152:155], a[148:151], v[48:63]
    ds_read_b64_tr_b16 a[220:221], v21 offset:4096
    ds_read_b64_tr_b16 a[222:223], v21 offset:5120
    v_mfma_f32_32x32x16_bf16 v[64:79], a[156:159], a[144:147], v[64:79]
    ds_read_b128 a[224:227], v18 offset:0
    ds_read_b64_tr_b16 a[232:233], v20 offset:8192
    buffer_load_dwordx4 v11, s[8:11], s48 offen offset:3072 lds
    v_mfma_f32_32x32x16_bf16 v[80:95], a[156:159], a[148:151], v[80:95]
    ds_read_b64_tr_b16 a[234:235], v20 offset:9216
    ds_read_b128 a[228:231], v18 offset:4096
    v_mfma_f32_32x32x16_bf16 v[32:47], a[168:171], a[160:163], v[32:47]
    ds_read_b64_tr_b16 a[236:237], v21 offset:8192
    ds_read_b64_tr_b16 a[238:239], v21 offset:9216
    s_add_u32 m0, s71, 0x4000
    s_lshl_b32 s49, s37, 17
    s_add_u32 s49, s49, s39
    buffer_load_dwordx4 v12, s[12:15], s49 offen lds
    v_mfma_f32_32x32x16_bf16 v[48:63], a[168:171], a[164:167], v[48:63]
    ds_read_b128 a[240:243], v19 offset:0
    ds_read_b64_tr_b16 a[248:249], v20 offset:12288
    v_mfma_f32_32x32x16_bf16 v[64:79], a[172:175], a[160:163], v[64:79]
    ds_read_b64_tr_b16 a[250:251], v20 offset:13312
    ds_read_b128 a[244:247], v19 offset:4096
    buffer_load_dwordx4 v13, s[12:15], s49 offen offset:1024 lds
    v_mfma_f32_32x32x16_bf16 v[80:95], a[172:175], a[164:167], v[80:95]
    ds_read_b64_tr_b16 a[252:253], v21 offset:12288
    ds_read_b64_tr_b16 a[254:255], v21 offset:13312
    v_mfma_f32_32x32x16_bf16 v[32:47], a[184:187], a[176:179], v[32:47]
    buffer_load_dwordx4 v14, s[12:15], s49 offen offset:2048 lds
    v_add_u32 v16, 0xfffe0000, v16
    v_add_u32 v17, 0xfffe0000, v17
    v_mfma_f32_32x32x16_bf16 v[48:63], a[184:187], a[180:183], v[48:63]
    v_add_u32 v18, 0xfffe0000, v18
    v_add_u32 v19, 0xfffe0000, v19
    v_mfma_f32_32x32x16_bf16 v[64:79], a[188:191], a[176:179], v[64:79]
    buffer_load_dwordx4 v15, s[12:15], s49 offen offset:3072 lds
    v_add_u32 v20, 0xfffe0000, v20
    v_add_u32 v21, 0xfffe0000, v21
    v_mfma_f32_32x32x16_bf16 v[80:95], a[188:191], a[180:183], v[80:95]
    s_add_u32 s37, s37, 1
    s_and_b32 s37, s37, 15
    s_add_u32 s71, s71, 0x8000
    s_cmp_eq_u32 s71, s32
    s_cselect_b32 s71, s36, s71
    s_cmp_lg_u32 s20, 0
    s_cbranch_scc1 L_at_nosig
    s_and_b32 s50, s2, 63
    s_lshl_b32 s50, s50, 2
    v_mov_b32 v24, 1
    v_mov_b32 v25, 0
    s_mov_b64 exec, 1
    buffer_atomic_add v24, v25, s[60:63], s50 offen sc1
    s_mov_b64 exec, -1
L_at_nosig:
    s_cmp_eq_u32 s20, s23
    s_waitcnt vmcnt(24) lgkmcnt(0)
    s_cbranch_scc1 L_at_w10
    s_waitcnt vmcnt(8)
L_at_w10:
    s_barrier
    v_mfma_f32_32x32x16_bf16 v[32:47], a[200:203], a[192:195], v[32:47]
    ds_read_b128 a[128:131], v16 offset:0
    ds_read_b64_tr_b16 a[136:137], v20 offset:0
    s_mov_b32 m0, s71
    s_lshl_b32 s48, s37, 7
    s_add_u32 s48, s48, s38
    buffer_load_dwordx4 v8, s[8:11], s48 offen lds
    v_mov_b32 v23, 0xdddddddd
    v_mfma_f32_32x32x16_bf16 v[48:63], a[200:203], a[196:199], v[48:63]
    ds_read_b64_tr_b16 a[138:139], v20 offset:1024
    ds_read_b128 a[132:135], v16 offset:4096
    v_and_b32 v24, 15, v1
    v_mfma_f32_32x32x16_bf16 v[64:79], a[204:207], a[192:195], v[64:79]
    ds_read_b64_tr_b16 a[140:141], v21 offset:0
    ds_read_b64_tr_b16 a[142:143], v21 offset:1024
    buffer_load_dwordx4 v9, s[8:11], s48 offen offset:1024 lds
    v_mov_b32 v25, 0x3f803f80
    v_mfma_f32_32x32x16_bf16 v[80:95], a[204:207], a[196:199], v[80:95]
    ds_read_b128 a[144:147], v17 offset:0
    ds_read_b64_tr_b16 a[152:153], v20 offset:4096
    v_cmp_eq_u32 vcc, 0, v24
    v_mfma_f32_32x32x16_bf16 v[32:47], a[216:219], a[208:211], v[32:47]
    ds_read_b64_tr_b16 a[154:155], v20 offset:5120
    ds_read_b128 a[148:151], v17 offset:4096
    buffer_load_dwordx4 v10, s[8:11], s48 offen offset:2048 lds
    s_nop 1
    v_mfma_f32_32x32x16_bf16 v[48:63], a[216:219], a[212:215], v[48:63]
    ds_read_b64_tr_b16 a[156:157], v21 offset:4096
    ds_read_b64_tr_b16 a[158:159], v21 offset:5120
    v_cndmask_b32 v31, 0, v25, vcc
    v_mfma_f32_32x32x16_bf16 v[64:79], a[220:223], a[208:211], v[64:79]
    ds_read_b128 a[160:163], v18 offset:0
    ds_read_b64_tr_b16 a[168:169], v20 offset:8192
    buffer_load_dwordx4 v11, s[8:11], s48 offen offset:3072 lds
    v_cmp_eq_u32 vcc, 4, v24
    v_mfma_f32_32x32x16_bf16 v[80:95], a[220:223], a[212:215], v[80:95]
    ds_read_b64_tr_b16 a[170:171], v20 offset:9216
    ds_read_b128 a[164:167], v18 offset:4096
    s_nop 1
    v_mfma_f32_32x32x16_bf16 v[32:47], a[232:235], a[224:227], v[32:47]
    ds_read_b64_tr_b16 a[172:173], v21 offset:8192
    ds_read_b64_tr_b16 a[174:175], v21 offset:9216
    s_add_u32 m0, s71, 0x4000
    s_lshl_b32 s49, s37, 17
    s_add_u32 s49, s49, s39
    buffer_load_dwordx4 v12, s[12:15], s49 offen lds
    v_cndmask_b32 v25, 0, v25, vcc
    v_mfma_f32_32x32x16_bf16 v[48:63], a[232:235], a[228:231], v[48:63]
    ds_read_b128 a[176:179], v19 offset:0
    ds_read_b64_tr_b16 a[184:185], v20 offset:12288
    v_accvgpr_write_b32 a48, v31
    v_mfma_f32_32x32x16_bf16 v[64:79], a[236:239], a[224:227], v[64:79]
    ds_read_b64_tr_b16 a[186:187], v20 offset:13312
    ds_read_b128 a[180:183], v19 offset:4096
    buffer_load_dwordx4 v13, s[12:15], s49 offen offset:1024 lds
    v_accvgpr_write_b32 a49, v31
    v_mfma_f32_32x32x16_bf16 v[80:95], a[236:239], a[228:231], v[80:95]
    ds_read_b64_tr_b16 a[188:189], v21 offset:12288
    ds_read_b64_tr_b16 a[190:191], v21 offset:13312
    v_accvgpr_write_b32 a50, v25
    v_mfma_f32_32x32x16_bf16 v[32:47], a[248:251], a[240:243], v[32:47]
    buffer_load_dwordx4 v14, s[12:15], s49 offen offset:2048 lds
    v_accvgpr_write_b32 a51, v25
    v_mfma_f32_32x32x16_bf16 v[48:63], a[248:251], a[244:247], v[48:63]
    v_accvgpr_write_b32 a0, 0
    v_mfma_f32_32x32x16_bf16 v[64:79], a[252:255], a[240:243], v[64:79]
    buffer_load_dwordx4 v15, s[12:15], s49 offen offset:3072 lds
    v_accvgpr_write_b32 a1, 0
    v_mfma_f32_32x32x16_bf16 v[80:95], a[252:255], a[244:247], v[80:95]
    s_add_u32 s37, s37, 1
    s_and_b32 s37, s37, 15
    s_add_u32 s71, s71, 0x8000
    s_cmp_eq_u32 s71, s32
    s_cselect_b32 s71, s36, s71
    v_accvgpr_write_b32 a2, 0
    s_cmp_eq_u32 s20, s23
    s_waitcnt vmcnt(24) lgkmcnt(0)
    s_cbranch_scc1 L_at_w11
    s_waitcnt vmcnt(8)
L_at_w11:
    s_barrier
    v_mfma_f32_32x32x16_bf16 v[32:47], a[136:139], a[128:131], v[32:47]
    ds_read_b128 a[192:195], v16 offset:32768
    ds_read_b64_tr_b16 a[200:201], v20 offset:32768
    s_mov_b32 m0, s71
    s_lshl_b32 s48, s37, 7
    s_add_u32 s48, s48, s38
    buffer_load_dwordx4 v8, s[8:11], s48 offen lds
    v_accvgpr_write_b32 a3, 0
    v_mfma_f32_32x32x16_bf16 v[48:63], a[136:139], a[132:135], v[48:63]
    ds_read_b64_tr_b16 a[202:203], v20 offset:33792
    ds_read_b128 a[196:199], v16 offset:36864
    v_accvgpr_write_b32 a4, 0
    v_mfma_f32_32x32x16_bf16 v[64:79], a[140:143], a[128:131], v[64:79]
    ds_read_b64_tr_b16 a[204:205], v21 offset:32768
    ds_read_b64_tr_b16 a[206:207], v21 offset:33792
    buffer_load_dwordx4 v9, s[8:11], s48 offen offset:1024 lds
    v_accvgpr_write_b32 a5, 0
    v_mfma_f32_32x32x16_bf16 v[80:95], a[140:143], a[132:135], v[80:95]
    ds_read_b128 a[208:211], v17 offset:32768
    ds_read_b64_tr_b16 a[216:217], v20 offset:36864
    v_accvgpr_write_b32 a6, 0
    v_mfma_f32_32x32x16_bf16 v[32:47], a[152:155], a[144:147], v[32:47]
    ds_read_b64_tr_b16 a[218:219], v20 offset:37888
    ds_read_b128 a[212:215], v17 offset:36864
    buffer_load_dwordx4 v10, s[8:11], s48 offen offset:2048 lds
    v_accvgpr_write_b32 a7, 0
    v_mfma_f32_32x32x16_bf16 v[48:63], a[152:155], a[148:151], v[48:63]
    ds_read_b64_tr_b16 a[220:221], v21 offset:36864
    ds_read_b64_tr_b16 a[222:223], v21 offset:37888
    v_accvgpr_write_b32 a8, 0
    v_mfma_f32_32x32x16_bf16 v[64:79], a[156:159], a[144:147], v[64:79]
    ds_read_b128 a[224:227], v18 offset:32768
    ds_read_b64_tr_b16 a[232:233], v20 offset:40960
    buffer_load_dwordx4 v11, s[8:11], s48 offen offset:3072 lds
    v_accvgpr_write_b32 a9, 0
    v_mfma_f32_32x32x16_bf16 v[80:95], a[156:159], a[148:151], v[80:95]
    ds_read_b64_tr_b16 a[234:235], v20 offset:41984
    ds_read_b128 a[228:231], v18 offset:36864
    v_accvgpr_write_b32 a10, 0
    v_mfma_f32_32x32x16_bf16 v[32:47], a[168:171], a[160:163], v[32:47]
    ds_read_b64_tr_b16 a[236:237], v21 offset:40960
    ds_read_b64_tr_b16 a[238:239], v21 offset:41984
    s_add_u32 m0, s71, 0x4000
    s_lshl_b32 s49, s37, 17
    s_add_u32 s49, s49, s39
    buffer_load_dwordx4 v12, s[12:15], s49 offen lds
    v_accvgpr_write_b32 a11, 0
    v_mfma_f32_32x32x16_bf16 v[48:63], a[168:171], a[164:167], v[48:63]
    ds_read_b128 a[240:243], v19 offset:32768
    ds_read_b64_tr_b16 a[248:249], v20 offset:45056
    v_accvgpr_write_b32 a12, 0
    v_mfma_f32_32x32x16_bf16 v[64:79], a[172:175], a[160:163], v[64:79]
    ds_read_b64_tr_b16 a[250:251], v20 offset:46080
    ds_read_b128 a[244:247], v19 offset:36864
    buffer_load_dwordx4 v13, s[12:15], s49 offen offset:1024 lds
    v_accvgpr_write_b32 a13, 0
    v_mfma_f32_32x32x16_bf16 v[80:95], a[172:175], a[164:167], v[80:95]
    ds_read_b64_tr_b16 a[252:253], v21 offset:45056
    ds_read_b64_tr_b16 a[254:255], v21 offset:46080
    v_accvgpr_write_b32 a14, 0
    v_mfma_f32_32x32x16_bf16 v[32:47], a[184:187], a[176:179], v[32:47]
    buffer_load_dwordx4 v14, s[12:15], s49 offen offset:2048 lds
    v_accvgpr_write_b32 a15, 0
    v_add_u32 v16, 0x10000, v16
    v_add_u32 v17, 0x10000, v17
    v_mfma_f32_32x32x16_bf16 v[48:63], a[184:187], a[180:183], v[48:63]
    v_accvgpr_write_b32 a40, 0
    v_add_u32 v18, 0x10000, v18
    v_add_u32 v19, 0x10000, v19
    v_mfma_f32_32x32x16_bf16 v[64:79], a[188:191], a[176:179], v[64:79]
    buffer_load_dwordx4 v15, s[12:15], s49 offen offset:3072 lds
    v_accvgpr_write_b32 a41, 0
    v_add_u32 v20, 0x10000, v20
    v_add_u32 v21, 0x10000, v21
    v_mfma_f32_32x32x16_bf16 v[80:95], a[188:191], a[180:183], v[80:95]
    s_add_u32 s37, s37, 1
    s_and_b32 s37, s37, 15
    s_add_u32 s71, s71, 0x8000
    s_cmp_eq_u32 s71, s32
    s_cselect_b32 s71, s36, s71
    v_accvgpr_write_b32 a42, 0
    s_cmp_eq_u32 s20, s23
    s_waitcnt vmcnt(24) lgkmcnt(0)
    s_cbranch_scc1 L_at_w12
    s_waitcnt vmcnt(8)
L_at_w12:
    s_barrier
    v_mfma_f32_32x32x16_bf16 v[32:47], a[200:203], a[192:195], v[32:47]
    ds_read_b128 a[128:131], v16 offset:0
    ds_read_b64_tr_b16 a[136:137], v20 offset:0
    s_mov_b32 m0, s71
    s_lshl_b32 s48, s37, 7
    s_add_u32 s48, s48, s38
    buffer_load_dwordx4 v8, s[8:11], s48 offen lds
    v_mov_b64 v[160:161], 0
    v_mfma_f32_32x32x16_bf16 v[48:63], a[200:203], a[196:199], v[48:63]
    ds_read_b64_tr_b16 a[138:139], v20 offset:1024
    ds_read_b128 a[132:135], v16 offset:4096
    v_mov_b64 v[162:163], 0
    v_mfma_f32_32x32x16_bf16 v[64:79], a[204:207], a[192:195], v[64:79]
    ds_read_b64_tr_b16 a[140:141], v21 offset:0
    ds_read_b64_tr_b16 a[142:143], v21 offset:1024
    buffer_load_dwordx4 v9, s[8:11], s48 offen offset:1024 lds
    v_mov_b64 v[164:165], 0
    v_mfma_f32_32x32x16_bf16 v[80:95], a[204:207], a[196:199], v[80:95]
    ds_read_b128 a[144:147], v17 offset:0
    ds_read_b64_tr_b16 a[152:153], v20 offset:4096
    v_mov_b64 v[166:167], 0
    v_mfma_f32_32x32x16_bf16 v[32:47], a[216:219], a[208:211], v[32:47]
    ds_read_b64_tr_b16 a[154:155], v20 offset:5120
    ds_read_b128 a[148:151], v17 offset:4096
    buffer_load_dwordx4 v10, s[8:11], s48 offen offset:2048 lds
    v_mov_b64 v[168:169], 0
    v_mfma_f32_32x32x16_bf16 v[48:63], a[216:219], a[212:215], v[48:63]
    ds_read_b64_tr_b16 a[156:157], v21 offset:4096
    ds_read_b64_tr_b16 a[158:159], v21 offset:5120
    v_mov_b64 v[170:171], 0
    v_mfma_f32_32x32x16_bf16 v[64:79], a[220:223], a[208:211], v[64:79]
    ds_read_b128 a[160:163], v18 offset:0
    ds_read_b64_tr_b16 a[168:169], v20 offset:8192
    buffer_load_dwordx4 v11, s[8:11], s48 offen offset:3072 lds
    v_mov_b64 v[172:173], 0
    v_mfma_f32_32x32x16_bf16 v[80:95], a[220:223], a[212:215], v[80:95]
    ds_read_b64_tr_b16 a[170:171], v20 offset:9216
    ds_read_b128 a[164:167], v18 offset:4096
    v_mov_b64 v[174:175], 0
    v_mfma_f32_32x32x16_bf16 v[32:47], a[232:235], a[224:227], v[32:47]
    ds_read_b64_tr_b16 a[172:173], v21 offset:8192
    ds_read_b64_tr_b16 a[174:175], v21 offset:9216
    s_add_u32 m0, s71, 0x4000
    s_lshl_b32 s49, s37, 17
    s_add_u32 s49, s49, s39
    buffer_load_dwordx4 v12, s[12:15], s49 offen lds
    v_mov_b64 v[176:177], 0
    v_mfma_f32_32x32x16_bf16 v[48:63], a[232:235], a[228:231], v[48:63]
    ds_read_b128 a[176:179], v19 offset:0
    ds_read_b64_tr_b16 a[184:185], v20 offset:12288
    v_mov_b64 v[178:179], 0
    v_mfma_f32_32x32x16_bf16 v[64:79], a[236:239], a[224:227], v[64:79]
    ds_read_b64_tr_b16 a[186:187], v20 offset:13312
    ds_read_b128 a[180:183], v19 offset:4096
    buffer_load_dwordx4 v13, s[12:15], s49 offen offset:1024 lds
    v_mov_b64 v[180:181], 0
    v_mfma_f32_32x32x16_bf16 v[80:95], a[236:239], a[228:231], v[80:95]
    ds_read_b64_tr_b16 a[188:189], v21 offset:12288
    ds_read_b64_tr_b16 a[190:191], v21 offset:13312
    v_mov_b64 v[182:183], 0
    v_mfma_f32_32x32x16_bf16 v[32:47], a[248:251], a[240:243], v[32:47]
    buffer_load_dwordx4 v14, s[12:15], s49 offen offset:2048 lds
    v_mov_b64 v[184:185], 0
    v_mfma_f32_32x32x16_bf16 v[48:63], a[248:251], a[244:247], v[48:63]
    v_mov_b64 v[186:187], 0
    v_mfma_f32_32x32x16_bf16 v[64:79], a[252:255], a[240:243], v[64:79]
    buffer_load_dwordx4 v15, s[12:15], s49 offen offset:3072 lds
    v_mov_b64 v[188:189], 0
    v_mfma_f32_32x32x16_bf16 v[80:95], a[252:255], a[244:247], v[80:95]
    s_add_u32 s37, s37, 1
    s_and_b32 s37, s37, 15
    s_add_u32 s71, s71, 0x8000
    s_cmp_eq_u32 s71, s32
    s_cselect_b32 s71, s36, s71
    v_mov_b64 v[190:191], 0
    s_cmp_eq_u32 s20, s23
    s_waitcnt vmcnt(24) lgkmcnt(0)
    s_cbranch_scc1 L_at_w13
    s_waitcnt vmcnt(8)
L_at_w13:
    s_barrier
    v_mfma_f32_32x32x16_bf16 v[32:47], a[136:139], a[128:131], v[32:47]
    ds_read_b128 a[192:195], v16 offset:32768
    ds_read_b64_tr_b16 a[200:201], v20 offset:32768
    s_mov_b32 m0, s71
    s_lshl_b32 s48, s37, 7
    s_add_u32 s48, s48, s38
    buffer_load_dwordx4 v8, s[8:11], s48 offen lds
    v_mov_b64 v[192:193], 0
    v_mfma_f32_32x32x16_bf16 v[48:63], a[136:139], a[132:135], v[48:63]
    ds_read_b64_tr_b16 a[202:203], v20 offset:33792
    ds_read_b128 a[196:199], v16 offset:36864
    v_mov_b64 v[194:195], 0
    v_mfma_f32_32x32x16_bf16 v[64:79], a[140:143], a[128:131], v[64:79]
    ds_read_b64_tr_b16 a[204:205], v21 offset:32768
    ds_read_b64_tr_b16 a[206:207], v21 offset:33792
    buffer_load_dwordx4 v9, s[8:11], s48 offen offset:1024 lds
    v_mov_b64 v[196:197], 0
    v_mfma_f32_32x32x16_bf16 v[80:95], a[140:143], a[132:135], v[80:95]
    ds_read_b128 a[208:211], v17 offset:32768
    ds_read_b64_tr_b16 a[216:217], v20 offset:36864
    v_mov_b64 v[198:199], 0
    v_mfma_f32_32x32x16_bf16 v[32:47], a[152:155], a[144:147], v[32:47]
    ds_read_b64_tr_b16 a[218:219], v20 offset:37888
    ds_read_b128 a[212:215], v17 offset:36864
    buffer_load_dwordx4 v10, s[8:11], s48 offen offset:2048 lds
    v_mov_b64 v[200:201], 0
    v_mfma_f32_32x32x16_bf16 v[48:63], a[152:155], a[148:151], v[48:63]
    ds_read_b64_tr_b16 a[220:221], v21 offset:36864
    ds_read_b64_tr_b16 a[222:223], v21 offset:37888
    v_mov_b64 v[202:203], 0
    v_mfma_f32_32x32x16_bf16 v[64:79], a[156:159], a[144:147], v[64:79]
    ds_read_b128 a[224:227], v18 offset:32768
    ds_read_b64_tr_b16 a[232:233], v20 offset:40960
    buffer_load_dwordx4 v11, s[8:11], s48 offen offset:3072 lds
    v_mov_b64 v[204:205], 0
    v_mfma_f32_32x32x16_bf16 v[80:95], a[156:159], a[148:151], v[80:95]
    ds_read_b64_tr_b16 a[234:235], v20 offset:41984
    ds_read_b128 a[228:231], v18 offset:36864
    v_mov_b64 v[206:207], 0
    v_mfma_f32_32x32x16_bf16 v[32:47], a[168:171], a[160:163], v[32:47]
    ds_read_b64_tr_b16 a[236:237], v21 offset:40960
    ds_read_b64_tr_b16 a[238:239], v21 offset:41984
    s_add_u32 m0, s71, 0x4000
    s_lshl_b32 s49, s37, 17
    s_add_u32 s49, s49, s39
    buffer_load_dwordx4 v12, s[12:15], s49 offen lds
    v_mov_b64 v[208:209], 0
    v_mfma_f32_32x32x16_bf16 v[48:63], a[168:171], a[164:167], v[48:63]
    ds_read_b128 a[240:243], v19 offset:32768
    ds_read_b64_tr_b16 a[248:249], v20 offset:45056
    v_mov_b64 v[210:211], 0
    v_mfma_f32_32x32x16_bf16 v[64:79], a[172:175], a[160:163], v[64:79]
    ds_read_b64_tr_b16 a[250:251], v20 offset:46080
    ds_read_b128 a[244:247], v19 offset:36864
    buffer_load_dwordx4 v13, s[12:15], s49 offen offset:1024 lds
    v_mov_b64 v[212:213], 0
    v_mfma_f32_32x32x16_bf16 v[80:95], a[172:175], a[164:167], v[80:95]
    ds_read_b64_tr_b16 a[252:253], v21 offset:45056
    ds_read_b64_tr_b16 a[254:255], v21 offset:46080
    v_mov_b64 v[214:215], 0
    v_mfma_f32_32x32x16_bf16 v[32:47], a[184:187], a[176:179], v[32:47]
    buffer_load_dwordx4 v14, s[12:15], s49 offen offset:2048 lds
    v_mov_b64 v[216:217], 0
    v_add_u32 v16, 0x10000, v16
    v_add_u32 v17, 0x10000, v17
    v_mfma_f32_32x32x16_bf16 v[48:63], a[184:187], a[180:183], v[48:63]
    v_mov_b64 v[218:219], 0
    v_add_u32 v18, 0x10000, v18
    v_add_u32 v19, 0x10000, v19
    v_mfma_f32_32x32x16_bf16 v[64:79], a[188:191], a[176:179], v[64:79]
    buffer_load_dwordx4 v15, s[12:15], s49 offen offset:3072 lds
    v_mov_b64 v[220:221], 0
    v_add_u32 v20, 0x10000, v20
    v_add_u32 v21, 0x10000, v21
    v_mfma_f32_32x32x16_bf16 v[80:95], a[188:191], a[180:183], v[80:95]
    s_add_u32 s37, s37, 1
    s_and_b32 s37, s37, 15
    s_add_u32 s71, s71, 0x8000
    s_cmp_eq_u32 s71, s32
    s_cselect_b32 s71, s36, s71
    v_mov_b64 v[222:223], 0
    s_cmp_eq_u32 s20, s23
    s_waitcnt vmcnt(24) lgkmcnt(0)
    s_cbranch_scc1 L_at_w14
    s_waitcnt vmcnt(8)
L_at_w14:
    s_barrier
    v_mfma_f32_32x32x16_bf16 v[32:47], a[200:203], a[192:195], v[32:47]
    ds_read_b128 a[128:131], v16 offset:0
    ds_read_b64_tr_b16 a[136:137], v20 offset:0
    s_mov_b32 m0, s71
    s_lshl_b32 s48, s37, 7
    s_add_u32 s48, s48, s38
    buffer_load_dwordx4 v8, s[8:11], s48 offen lds
    v_accvgpr_write_b32 a43, 0
    v_mfma_f32_32x32x16_bf16 v[48:63], a[200:203], a[196:199], v[48:63]
    ds_read_b64_tr_b16 a[138:139], v20 offset:1024
    ds_read_b128 a[132:135], v16 offset:4096
    v_accvgpr_write_b32 a44, 0
    v_mfma_f32_32x32x16_bf16 v[64:79], a[204:207], a[192:195], v[64:79]
    ds_read_b64_tr_b16 a[140:141], v21 offset:0
    ds_read_b64_tr_b16 a[142:143], v21 offset:1024
    buffer_load_dwordx4 v9, s[8:11], s48 offen offset:1024 lds
    v_accvgpr_write_b32 a45, 0
    v_mfma_f32_32x32x16_bf16 v[80:95], a[204:207], a[196:199], v[80:95]
    ds_read_b128 a[144:147], v17 offset:0
    ds_read_b64_tr_b16 a[152:153], v20 offset:4096
    v_accvgpr_write_b32 a46, 0
    v_mfma_f32_32x32x16_bf16 v[32:47], a[216:219], a[208:211], v[32:47]
    ds_read_b64_tr_b16 a[154:155], v20 offset:5120
    ds_read_b128 a[148:151], v17 offset:4096
    buffer_load_dwordx4 v10, s[8:11], s48 offen offset:2048 lds
    v_accvgpr_write_b32 a47, 0
    v_mfma_f32_32x32x16_bf16 v[48:63], a[216:219], a[212:215], v[48:63]
    ds_read_b64_tr_b16 a[156:157], v21 offset:4096
    ds_read_b64_tr_b16 a[158:159], v21 offset:5120
    v_mov_b32 v22, v28
    v_mfma_f32_32x32x16_bf16 v[64:79], a[220:223], a[208:211], v[64:79]
    ds_read_b128 a[160:163], v18 offset:0
    ds_read_b64_tr_b16 a[168:169], v20 offset:8192
    buffer_load_dwordx4 v11, s[8:11], s48 offen offset:3072 lds
    v_mfma_f32_32x32x16_bf16 v[80:95], a[220:223], a[212:215], v[80:95]
    ds_read_b64_tr_b16 a[170:171], v20 offset:9216
    ds_read_b128 a[164:167], v18 offset:4096
    v_mfma_f32_32x32x16_bf16 v[32:47], a[232:235], a[224:227], v[32:47]
    ds_read_b64_tr_b16 a[172:173], v21 offset:8192
    ds_read_b64_tr_b16 a[174:175], v21 offset:9216
    s_add_u32 m0, s71, 0x4000
    s_lshl_b32 s49, s37, 17
    s_add_u32 s49, s49, s39
    buffer_load_dwordx4 v12, s[12:15], s49 offen lds
    v_mfma_f32_32x32x16_bf16 v[48:63], a[232:235], a[228:231], v[48:63]
    ds_read_b128 a[176:179], v19 offset:0
    ds_read_b64_tr_b16 a[184:185], v20 offset:12288
    v_mfma_f32_32x32x16_bf16 v[64:79], a[236:239], a[224:227], v[64:79]
    ds_read_b64_tr_b16 a[186:187], v20 offset:13312
    ds_read_b128 a[180:183], v19 offset:4096
    buffer_load_dwordx4 v13, s[12:15], s49 offen offset:1024 lds
    v_mfma_f32_32x32x16_bf16 v[80:95], a[236:239], a[228:231], v[80:95]
    ds_read_b64_tr_b16 a[188:189], v21 offset:12288
    ds_read_b64_tr_b16 a[190:191], v21 offset:13312
    v_mfma_f32_32x32x16_bf16 v[32:47], a[248:251], a[240:243], v[32:47]
    buffer_load_dwordx4 v14, s[12:15], s49 offen offset:2048 lds
    v_add_u32 v16, 0xfffe0000, v16
    v_add_u32 v17, 0xfffe0000, v17
    v_mfma_f32_32x32x16_bf16 v[48:63], a[248:251], a[244:247], v[48:63]
    v_add_u32 v18, 0xfffe0000, v18
    v_add_u32 v19, 0xfffe0000, v19
    v_mfma_f32_32x32x16_bf16 v[64:79], a[252:255], a[240:243], v[64:79]
    buffer_load_dwordx4 v15, s[12:15], s49 offen offset:3072 lds
    v_add_u32 v20, 0xfffe0000, v20
    v_add_u32 v21, 0xfffe0000, v21
    v_mfma_f32_32x32x16_bf16 v[80:95], a[252:255], a[244:247], v[80:95]
    s_add_u32 s37, s37, 1
    s_and_b32 s37, s37, 15
    s_add_u32 s71, s71, 0x8000
    s_cmp_eq_u32 s71, s32
    s_cselect_b32 s71, s36, s71
    s_cmp_eq_u32 s20, s23
    s_waitcnt vmcnt(24) lgkmcnt(0)
    s_cbranch_scc1 L_at_w15
    s_waitcnt vmcnt(8)
L_at_w15:
    s_barrier
    v_mfma_f32_32x32x16_bf16 v[32:47], a[136:139], a[128:131], v[32:47]
    ds_read_b128 a[192:195], v16 offset:0
    ds_read_b64_tr_b16 a[200:201], v20 offset:0
    s_mov_b32 m0, s71
    s_lshl_b32 s48, s37, 7
    s_add_u32 s48, s48, s38
    buffer_load_dwordx4 v8, s[8:11], s48 offen lds
    v_mfma_f32_32x32x16_bf16 v[48:63], a[136:139], a[132:135], v[48:63]
    ds_read_b64_tr_b16 a[202:203], v20 offset:1024
    ds_read_b128 a[196:199], v16 offset:4096
    v_mfma_f32_32x32x16_bf16 v[64:79], a[140:143], a[128:131], v[64:79]
    ds_read_b64_tr_b16 a[204:205], v21 offset:0
    ds_read_b64_tr_b16 a[206:207], v21 offset:1024
    buffer_load_dwordx4 v9, s[8:11], s48 offen offset:1024 lds
    v_mfma_f32_32x32x16_bf16 v[80:95], a[140:143], a[132:135], v[80:95]
    ds_read_b128 a[208:211], v17 offset:0
    ds_read_b64_tr_b16 a[216:217], v20 offset:4096
    v_mfma_f32_32x32x16_bf16 v[32:47], a[152:155], a[144:147], v[32:47]
    ds_read_b64_tr_b16 a[218:219], v20 offset:5120
    ds_read_b128 a[212:215], v17 offset:4096
    buffer_load_dwordx4 v10, s[8:11], s48 offen offset:2048 lds
    v_mfma_f32_32x32x16_bf16 v[48:63], a[152:155], a[148:151], v[48:63]
    ds_read_b64_tr_b16 a[220:221], v21 offset:4096
    ds_read_b64_tr_b16 a[222:223], v21 offset:5120
    v_mfma_f32_32x32x16_bf16 v[64:79], a[156:159], a[144:147], v[64:79]
    ds_read_b128 a[224:227], v18 offset:0
    ds_read_b64_tr_b16 a[232:233], v20 offset:8192
    buffer_load_dwordx4 v11, s[8:11], s48 offen offset:3072 lds
    v_mfma_f32_32x32x16_bf16 v[80:95], a[156:159], a[148:151], v[80:95]
    ds_read_b64_tr_b16 a[234:235], v20 offset:9216
    ds_read_b128 a[228:231], v18 offset:4096
    v_mfma_f32_32x32x16_bf16 v[32:47], a[168:171], a[160:163], v[32:47]
    ds_read_b64_tr_b16 a[236:237], v21 offset:8192
    ds_read_b64_tr_b16 a[238:239], v21 offset:9216
    s_add_u32 m0, s71, 0x4000
    s_lshl_b32 s49, s37, 17
    s_add_u32 s49, s49, s39
    buffer_load_dwordx4 v12, s[12:15], s49 offen lds
    v_mfma_f32_32x32x16_bf16 v[48:63], a[168:171], a[164:167], v[48:63]
    ds_read_b128 a[240:243], v19 offset:0
    ds_read_b64_tr_b16 a[248:249], v20 offset:12288
    v_mfma_f32_32x32x16_bf16 v[64:79], a[172:175], a[160:163], v[64:79]
    ds_read_b64_tr_b16 a[250:251], v20 offset:13312
    ds_read_b128 a[244:247], v19 offset:4096
    buffer_load_dwordx4 v13, s[12:15], s49 offen offset:1024 lds
    v_mfma_f32_32x32x16_bf16 v[80:95], a[172:175], a[164:167], v[80:95]
    ds_read_b64_tr_b16 a[252:253], v21 offset:12288
    ds_read_b64_tr_b16 a[254:255], v21 offset:13312
    v_mfma_f32_32x32x16_bf16 v[32:47], a[184:187], a[176:179], v[32:47]
    buffer_load_dwordx4 v14, s[12:15], s49 offen offset:2048 lds
    v_mfma_f32_32x32x16_bf16 v[48:63], a[184:187], a[180:183], v[48:63]
    v_mfma_f32_32x32x16_bf16 v[64:79], a[188:191], a[176:179], v[64:79]
    buffer_load_dwordx4 v15, s[12:15], s49 offen offset:3072 lds
    v_mfma_f32_32x32x16_bf16 v[80:95], a[188:191], a[180:183], v[80:95]
    s_add_u32 s37, s37, 1
    s_and_b32 s37, s37, 15
    s_add_u32 s71, s71, 0x8000
    s_cmp_eq_u32 s71, s32
    s_cselect_b32 s71, s36, s71
    s_cmp_eq_u32 s20, s23
    s_waitcnt vmcnt(24) lgkmcnt(0)
    s_cbranch_scc1 L_at_w16
    s_waitcnt vmcnt(8)
L_at_w16:
    s_barrier
    s_cmp_eq_u32 s20, s23
    s_cselect_b32 s10, 0, s10
    s_cselect_b32 s14, 0, s14
    s_cselect_b32 s71, 0x30000, s71
    v_mfma_f32_32x32x16_bf16 v[32:47], a[200:203], a[192:195], v[32:47]
    ds_read_b128 a[128:131], v16 offset:32768
    ds_read_b64_tr_b16 a[136:137], v20 offset:32768
    s_mov_b32 m0, s71
    s_lshl_b32 s48, s37, 7
    s_add_u32 s48, s48, s38
    buffer_load_dwordx4 v8, s[8:11], s48 offen lds
    v_lshlrev_b32 v31, 2, v1
    v_mfma_f32_32x32x16_bf16 v[48:63], a[200:203], a[196:199], v[48:63]
    ds_read_b64_tr_b16 a[138:139], v20 offset:33792
    ds_read_b128 a[132:135], v16 offset:36864
    v_mfma_f32_32x32x16_bf16 v[64:79], a[204:207], a[192:195], v[64:79]
    ds_read_b64_tr_b16 a[140:141], v21 offset:32768
    ds_read_b64_tr_b16 a[142:143], v21 offset:33792
    buffer_load_dwordx4 v9, s[8:11], s48 offen offset:1024 lds
    v_mfma_f32_32x32x16_bf16 v[80:95], a[204:207], a[196:199], v[80:95]
    ds_read_b128 a[144:147], v17 offset:32768
    ds_read_b64_tr_b16 a[152:153], v20 offset:36864
    v_mfma_f32_32x32x16_bf16 v[32:47], a[216:219], a[208:211], v[32:47]
    ds_read_b64_tr_b16 a[154:155], v20 offset:37888
    ds_read_b128 a[148:151], v17 offset:36864
    buffer_load_dwordx4 v10, s[8:11], s48 offen offset:2048 lds
    v_mfma_f32_32x32x16_bf16 v[48:63], a[216:219], a[212:215], v[48:63]
    ds_read_b64_tr_b16 a[156:157], v21 offset:36864
    ds_read_b64_tr_b16 a[158:159], v21 offset:37888
    v_mfma_f32_32x32x16_bf16 v[64:79], a[220:223], a[208:211], v[64:79]
    ds_read_b128 a[160:163], v18 offset:32768
    ds_read_b64_tr_b16 a[168:169], v20 offset:40960
    buffer_load_dwordx4 v11, s[8:11], s48 offen offset:3072 lds
    v_mfma_f32_32x32x16_bf16 v[80:95], a[220:223], a[212:215], v[80:95]
    ds_read_b64_tr_b16 a[170:171], v20 offset:41984
    ds_read_b128 a[164:167], v18 offset:36864
    v_mfma_f32_32x32x16_bf16 v[32:47], a[232:235], a[224:227], v[32:47]
    ds_read_b64_tr_b16 a[172:173], v21 offset:40960
    ds_read_b64_tr_b16 a[174:175], v21 offset:41984
    s_add_u32 m0, s71, 0x4000
    s_lshl_b32 s49, s37, 17
    s_add_u32 s49, s49, s39
    buffer_load_dwordx4 v12, s[12:15], s49 offen lds
    v_mfma_f32_32x32x16_bf16 v[48:63], a[232:235], a[228:231], v[48:63]
    ds_read_b128 a[176:179], v19 offset:32768
    ds_read_b64_tr_b16 a[184:185], v20 offset:45056
    v_mfma_f32_32x32x16_bf16 v[64:79], a[236:239], a[224:227], v[64:79]
    ds_read_b64_tr_b16 a[186:187], v20 offset:46080
    ds_read_b128 a[180:183], v19 offset:36864
    buffer_load_dwordx4 v13, s[12:15], s49 offen offset:1024 lds
    v_mfma_f32_32x32x16_bf16 v[80:95], a[236:239], a[228:231], v[80:95]
    ds_read_b64_tr_b16 a[188:189], v21 offset:45056
    ds_read_b64_tr_b16 a[190:191], v21 offset:46080
    v_mfma_f32_32x32x16_bf16 v[32:47], a[248:251], a[240:243], v[32:47]
    buffer_load_dwordx4 v14, s[12:15], s49 offen offset:2048 lds
    v_add_u32 v16, 0x10000, v16
    v_add_u32 v17, 0x10000, v17
    v_mfma_f32_32x32x16_bf16 v[48:63], a[248:251], a[244:247], v[48:63]
    v_add_u32 v18, 0x10000, v18
    v_add_u32 v19, 0x10000, v19
    v_mfma_f32_32x32x16_bf16 v[64:79], a[252:255], a[240:243], v[64:79]
    buffer_load_dwordx4 v15, s[12:15], s49 offen offset:3072 lds
    v_add_u32 v20, 0x10000, v20
    v_add_u32 v21, 0x10000, v21
    v_mfma_f32_32x32x16_bf16 v[80:95], a[252:255], a[244:247], v[80:95]
    s_add_u32 s37, s37, 1
    s_and_b32 s37, s37, 15
    s_add_u32 s71, s71, 0x8000
    s_cmp_eq_u32 s71, s32
    s_cselect_b32 s71, s36, s71
    buffer_load_dword v30, v31, s[60:63], 0 offen sc1
    s_cmp_eq_u32 s20, s23
    s_waitcnt vmcnt(24) lgkmcnt(0)
    s_cbranch_scc1 L_at_w17
    s_waitcnt vmcnt(9)
L_at_w17:
    s_barrier
    v_mfma_f32_32x32x16_bf16 v[32:47], a[136:139], a[128:131], v[32:47]
    ds_read_b128 a[192:195], v16 offset:0
    ds_read_b64_tr_b16 a[200:201], v20 offset:0
    s_mov_b32 m0, s71
    s_lshl_b32 s48, s37, 7
    s_add_u32 s48, s48, s38
    buffer_load_dwordx4 v8, s[8:11], s48 offen lds
    v_mfma_f32_32x32x16_bf16 v[48:63], a[136:139], a[132:135], v[48:63]
    ds_read_b64_tr_b16 a[202:203], v20 offset:1024
    ds_read_b128 a[196:199], v16 offset:4096
    v_mfma_f32_32x32x16_bf16 v[64:79], a[140:143], a[128:131], v[64:79]
    ds_read_b64_tr_b16 a[204:205], v21 offset:0
    ds_read_b64_tr_b16 a[206:207], v21 offset:1024
    buffer_load_dwordx4 v9, s[8:11], s48 offen offset:1024 lds
    v_mfma_f32_32x32x16_bf16 v[80:95], a[140:143], a[132:135], v[80:95]
    ds_read_b128 a[208:211], v17 offset:0
    ds_read_b64_tr_b16 a[216:217], v20 offset:4096
    v_mfma_f32_32x32x16_bf16 v[32:47], a[152:155], a[144:147], v[32:47]
    ds_read_b64_tr_b16 a[218:219], v20 offset:5120
    ds_read_b128 a[212:215], v17 offset:4096
    buffer_load_dwordx4 v10, s[8:11], s48 offen offset:2048 lds
    v_mfma_f32_32x32x16_bf16 v[48:63], a[152:155], a[148:151], v[48:63]
    ds_read_b64_tr_b16 a[220:221], v21 offset:4096
    ds_read_b64_tr_b16 a[222:223], v21 offset:5120
    v_mfma_f32_32x32x16_bf16 v[64:79], a[156:159], a[144:147], v[64:79]
    ds_read_b128 a[224:227], v18 offset:0
    ds_read_b64_tr_b16 a[232:233], v20 offset:8192
    buffer_load_dwordx4 v11, s[8:11], s48 offen offset:3072 lds
    v_mfma_f32_32x32x16_bf16 v[80:95], a[156:159], a[148:151], v[80:95]
    ds_read_b64_tr_b16 a[234:235], v20 offset:9216
    ds_read_b128 a[228:231], v18 offset:4096
    v_mfma_f32_32x32x16_bf16 v[32:47], a[168:171], a[160:163], v[32:47]
    ds_read_b64_tr_b16 a[236:237], v21 offset:8192
    ds_read_b64_tr_b16 a[238:239], v21 offset:9216
    s_add_u32 m0, s71, 0x4000
    s_lshl_b32 s49, s37, 17
    s_add_u32 s49, s49, s39
    buffer_load_dwordx4 v12, s[12:15], s49 offen lds
    v_mfma_f32_32x32x16_bf16 v[48:63], a[168:171], a[164:167], v[48:63]
    ds_read_b128 a[240:243], v19 offset:0
    ds_read_b64_tr_b16 a[248:249], v20 offset:12288
    v_mfma_f32_32x32x16_bf16 v[64:79], a[172:175], a[160:163], v[64:79]
    ds_read_b64_tr_b16 a[250:251], v20 offset:13312
    ds_read_b128 a[244:247], v19 offset:4096
    buffer_load_dwordx4 v13, s[12:15], s49 offen offset:1024 lds
    v_mfma_f32_32x32x16_bf16 v[80:95], a[172:175], a[164:167], v[80:95]
    ds_read_b64_tr_b16 a[252:253], v21 offset:12288
    ds_read_b64_tr_b16 a[254:255], v21 offset:13312
    v_mfma_f32_32x32x16_bf16 v[32:47], a[184:187], a[176:179], v[32:47]
    buffer_load_dwordx4 v14, s[12:15], s49 offen offset:2048 lds
    v_mfma_f32_32x32x16_bf16 v[48:63], a[184:187], a[180:183], v[48:63]
    v_mfma_f32_32x32x16_bf16 v[64:79], a[188:191], a[176:179], v[64:79]
    buffer_load_dwordx4 v15, s[12:15], s49 offen offset:3072 lds
    v_mfma_f32_32x32x16_bf16 v[80:95], a[188:191], a[180:183], v[80:95]
    s_add_u32 s37, s37, 1
    s_and_b32 s37, s37, 15
    s_add_u32 s71, s71, 0x8000
    s_cmp_eq_u32 s71, s32
    s_cselect_b32 s71, s36, s71
    s_cmp_eq_u32 s20, s23
    s_waitcnt vmcnt(24) lgkmcnt(0)
    s_cbranch_scc1 L_at_w18
    s_waitcnt vmcnt(8)
L_at_w18:
    s_barrier
    s_waitcnt vmcnt(8)
    v_cmp_gt_u32 vcc, 4, v30
    s_nop 4
    s_cmp_eq_u64 vcc, 0
    s_cbranch_scc1 L_at_flags_ok
    s_mov_b32 s50, 0
L_at_spin:
    s_add_u32 s50, s50, 1
    s_cmp_gt_u32 s50, 0x40000
    s_cbranch_scc1 L_at_flags_ok
    s_sleep 8
    buffer_load_dword v30, v31, s[60:63], 0 offen sc1
    s_waitcnt vmcnt(0)
    v_cmp_gt_u32 vcc, 4, v30
    s_nop 4
    s_cmp_eq_u64 vcc, 0
    s_cbranch_scc0 L_at_spin
L_at_flags_ok:
    v_mfma_f32_32x32x16_bf16 v[32:47], a[200:203], a[192:195], v[32:47]
    ds_read_b128 a[128:131], v16 offset:32768
    ds_read_b64_tr_b16 a[136:137], v20 offset:32768
    s_add_u32 m0, s36, 0
    s_mov_b32 s48, 0
    buffer_load_dwordx4 v29, s[44:47], s48 offen sc1 lds
    v_lshrrev_b32 v24, 3, v1
    v_mfma_f32_32x32x16_bf16 v[48:63], a[200:203], a[196:199], v[48:63]
    ds_read_b64_tr_b16 a[138:139], v20 offset:33792
    ds_read_b128 a[132:135], v16 offset:36864
    v_lshl_add_u32 v24, v4, 5, v24
    v_mfma_f32_32x32x16_bf16 v[64:79], a[204:207], a[192:195], v[64:79]
    ds_read_b64_tr_b16 a[140:141], v21 offset:32768
    ds_read_b64_tr_b16 a[142:143], v21 offset:33792
    buffer_load_dwordx4 v29, s[44:47], s48 offen offset:1024 sc1 lds
    v_lshlrev_b32 v24, 11, v24
    v_mfma_f32_32x32x16_bf16 v[80:95], a[204:207], a[196:199], v[80:95]
    ds_read_b128 a[144:147], v17 offset:32768
    ds_read_b64_tr_b16 a[152:153], v20 offset:36864
    v_bfe_u32 v25, v1, 4, 1
    v_mfma_f32_32x32x16_bf16 v[32:47], a[216:219], a[208:211], v[32:47]
    ds_read_b64_tr_b16 a[154:155], v20 offset:37888
    ds_read_b128 a[148:151], v17 offset:36864
    buffer_load_dwordx4 v29, s[44:47], s48 offen offset:2048 sc1 lds
    v_lshlrev_b32 v25, 2, v25
    v_mfma_f32_32x32x16_bf16 v[48:63], a[216:219], a[212:215], v[48:63]
    ds_read_b64_tr_b16 a[156:157], v21 offset:36864
    ds_read_b64_tr_b16 a[158:159], v21 offset:37888
    v_and_b32 v5, 7, v1
    v_mfma_f32_32x32x16_bf16 v[64:79], a[220:223], a[208:211], v[64:79]
    ds_read_b128 a[160:163], v18 offset:32768
    ds_read_b64_tr_b16 a[168:169], v20 offset:40960
    buffer_load_dwordx4 v29, s[44:47], s48 offen offset:3072 sc1 lds
    v_xor_b32 v5, v5, v25
    v_mfma_f32_32x32x16_bf16 v[80:95], a[220:223], a[212:215], v[80:95]
    ds_read_b64_tr_b16 a[170:171], v20 offset:41984
    ds_read_b128 a[164:167], v18 offset:36864
    v_lshl_add_u32 v12, v5, 4, v24
    v_mfma_f32_32x32x16_bf16 v[32:47], a[232:235], a[224:227], v[32:47]
    ds_read_b64_tr_b16 a[172:173], v21 offset:40960
    ds_read_b64_tr_b16 a[174:175], v21 offset:41984
    s_add_u32 m0, s36, 16384
    s_mov_b32 s49, 16384
    buffer_load_dwordx4 v29, s[44:47], s49 offen sc1 lds
    s_lshl_b32 s31, s28, 3
    s_add_u32 s31, s31, s30
    s_lshl_b32 s31, s31, 7
    v_mfma_f32_32x32x16_bf16 v[48:63], a[232:235], a[228:231], v[48:63]
    ds_read_b128 a[176:179], v19 offset:32768
    ds_read_b64_tr_b16 a[184:185], v20 offset:45056
    v_add_u32 v12, s31, v12
    v_mfma_f32_32x32x16_bf16 v[64:79], a[236:239], a[224:227], v[64:79]
    ds_read_b64_tr_b16 a[186:187], v20 offset:46080
    ds_read_b128 a[180:183], v19 offset:36864
    buffer_load_dwordx4 v29, s[44:47], s49 offen offset:1024 sc1 lds
    v_add_u32 v13, 15360, v12
    v_mfma_f32_32x32x16_bf16 v[80:95], a[236:239], a[228:231], v[80:95]
    ds_read_b64_tr_b16 a[188:189], v21 offset:45056
    ds_read_b64_tr_b16 a[190:191], v21 offset:46080
    v_add_u32 v14, 30720, v12
    v_mfma_f32_32x32x16_bf16 v[32:47], a[248:251], a[240:243], v[32:47]
    buffer_load_dwordx4 v29, s[44:47], s49 offen offset:2048 sc1 lds
    v_add_u32 v15, 46080, v12
    v_add_u32 v16, 0x10000, v16
    v_add_u32 v17, 0x10000, v17
    v_mfma_f32_32x32x16_bf16 v[48:63], a[248:251], a[244:247], v[48:63]
    v_add_u32 v18, 0x10000, v18
    v_add_u32 v19, 0x10000, v19
    v_mfma_f32_32x32x16_bf16 v[64:79], a[252:255], a[240:243], v[64:79]
    buffer_load_dwordx4 v29, s[44:47], s49 offen offset:3072 sc1 lds
    v_add_u32 v20, 0x10000, v20
    v_add_u32 v21, 0x10000, v21
    v_mfma_f32_32x32x16_bf16 v[80:95], a[252:255], a[244:247], v[80:95]
    s_cmp_eq_u32 s20, s23
    s_waitcnt vmcnt(24) lgkmcnt(0)
    s_cbranch_scc1 L_at_w19
    s_waitcnt vmcnt(8)
L_at_w19:
    s_barrier
    v_mfma_f32_32x32x16_bf16 v[32:47], a[136:139], a[128:131], v[32:47]
    ds_read_b128 a[192:195], v16 offset:0
    ds_read_b64_tr_b16 a[200:201], v20 offset:0
    s_add_u32 m0, s36, 32768
    s_mov_b32 s48, 32768
    buffer_load_dwordx4 v29, s[44:47], s48 offen sc1 lds
    v_mov_b32 v8, v29
    v_mfma_f32_32x32x16_bf16 v[48:63], a[136:139], a[132:135], v[48:63]
    ds_read_b64_tr_b16 a[202:203], v20 offset:1024
    ds_read_b128 a[196:199], v16 offset:4096
    v_mov_b32 v9, v29
    v_mfma_f32_32x32x16_bf16 v[64:79], a[140:143], a[128:131], v[64:79]
    ds_read_b64_tr_b16 a[204:205], v21 offset:0
    ds_read_b64_tr_b16 a[206:207], v21 offset:1024
    buffer_load_dwordx4 v29, s[44:47], s48 offen offset:1024 sc1 lds
    v_mov_b32 v10, v29
    v_mfma_f32_32x32x16_bf16 v[80:95], a[140:143], a[132:135], v[80:95]
    ds_read_b128 a[208:211], v17 offset:0
    ds_read_b64_tr_b16 a[216:217], v20 offset:4096
    v_mov_b32 v11, v29
    v_mfma_f32_32x32x16_bf16 v[32:47], a[152:155], a[144:147], v[32:47]
    ds_read_b64_tr_b16 a[218:219], v20 offset:5120
    ds_read_b128 a[212:215], v17 offset:4096
    buffer_load_dwordx4 v29, s[44:47], s48 offen offset:2048 sc1 lds
    s_mov_b32 s14, 0x200000
    v_mfma_f32_32x32x16_bf16 v[48:63], a[152:155], a[148:151], v[48:63]
    ds_read_b64_tr_b16 a[220:221], v21 offset:4096
    ds_read_b64_tr_b16 a[222:223], v21 offset:5120
    s_lshl_b32 s40, s29, 2
    s_lshl_b32 s41, s22, 1
    s_add_u32 s40, s40, s41
    v_mfma_f32_32x32x16_bf16 v[64:79], a[156:159], a[144:147], v[64:79]
    ds_read_b128 a[224:227], v18 offset:0
    ds_read_b64_tr_b16 a[232:233], v20 offset:8192
    buffer_load_dwordx4 v29, s[44:47], s48 offen offset:3072 sc1 lds
    s_lshl_b32 s40, s40, 17
    s_lshl_b32 s41, s28, 5
    s_lshl_b32 s50, s30, 2
    v_mfma_f32_32x32x16_bf16 v[80:95], a[156:159], a[148:151], v[80:95]
    ds_read_b64_tr_b16 a[234:235], v20 offset:9216
    ds_read_b128 a[228:231], v18 offset:4096
    s_add_u32 s41, s41, s50
    s_lshl_b32 s50, s21, 1
    s_add_u32 s41, s41, s50
    v_mfma_f32_32x32x16_bf16 v[32:47], a[168:171], a[160:163], v[32:47]
    ds_read_b64_tr_b16 a[236:237], v21 offset:8192
    ds_read_b64_tr_b16 a[238:239], v21 offset:9216
    s_add_u32 m0, s36, 49152
    s_mov_b32 s49, 49152
    buffer_load_dwordx4 v29, s[44:47], s49 offen sc1 lds
    s_lshl_b32 s41, s41, 11
    s_add_u32 s40, s40, s41
    s_add_u32 s40, s40, 1048576
    v_mfma_f32_32x32x16_bf16 v[48:63], a[168:171], a[164:167], v[48:63]
    ds_read_b128 a[240:243], v19 offset:0
    ds_read_b64_tr_b16 a[248:249], v20 offset:12288
    s_add_u32 s41, s40, 0x20000
    s_mov_b32 s42, s40
    v_mfma_f32_32x32x16_bf16 v[64:79], a[172:175], a[160:163], v[64:79]
    ds_read_b64_tr_b16 a[250:251], v20 offset:13312
    ds_read_b128 a[244:247], v19 offset:4096
    buffer_load_dwordx4 v29, s[44:47], s49 offen offset:1024 sc1 lds
    s_mov_b32 s56, s64
    s_mov_b32 s57, s65
    s_mov_b32 s58, 4194304
    v_mfma_f32_32x32x16_bf16 v[80:95], a[172:175], a[164:167], v[80:95]
    ds_read_b64_tr_b16 a[252:253], v21 offset:12288
    ds_read_b64_tr_b16 a[254:255], v21 offset:13312
    s_lshl_b32 s43, s29, 18
    s_lshl_b32 s50, s20, 16
    s_add_u32 s43, s43, s50
    v_mfma_f32_32x32x16_bf16 v[32:47], a[184:187], a[176:179], v[32:47]
    buffer_load_dwordx4 v29, s[44:47], s49 offen offset:2048 sc1 lds
    s_add_u32 s43, s43, s31
    v_bfe_u32 v24, v1, 2, 2
    v_lshl_add_u32 v25, v2, 2, v24
    v_lshlrev_b32 v25, 7, v25
    v_bfe_u32 v24, v1, 3, 1
    v_lshl_add_u32 v25, v24, 6, v25
    v_mfma_f32_32x32x16_bf16 v[48:63], a[184:187], a[180:183], v[48:63]
    s_lshl_b32 s50, s29, 2
    s_add_u32 s50, s50, s20
    s_lshl_b32 s50, s50, 17
    s_add_u32 s50, s50, 1048576
    s_lshl_b32 s51, s28, 16
    s_add_u32 s7, s50, s51
    v_bfe_u32 v24, v1, 4, 1
    v_lshl_add_u32 v25, v24, 5, v25
    v_and_b32 v24, 1, v1
    v_lshl_add_u32 v25, v24, 4, v25
    v_mfma_f32_32x32x16_bf16 v[64:79], a[188:191], a[176:179], v[64:79]
    buffer_load_dwordx4 v29, s[44:47], s49 offen offset:3072 sc1 lds
    s_add_u32 s8, s26, s7
    s_addc_u32 s9, s27, 0
    s_mov_b32 s10, 0x10000
    s_xor_b32 s51, s51, 0x10000
    s_add_u32 s7, s50, s51
    s_add_u32 s4, s26, s7
    s_addc_u32 s5, s27, 0
    v_bfe_u32 v24, v1, 1, 1
    v_lshl_add_u32 v16, v24, 3, v25
    v_xor_b32 v17, 64, v16
    v_add_u32 v24, s30, v1
    v_and_b32 v24, 7, v24
    v_mfma_f32_32x32x16_bf16 v[80:95], a[188:191], a[180:183], v[80:95]
    s_lshl_b32 s3, s30, 13
    s_lshl_b32 s6, s29, 7
    s_add_u32 s6, s6, 589824
    s_lshl_b32 s7, s28, 3
    s_mov_b32 s12, s72
    s_mov_b32 s13, s73
    v_xor_b32 v25, s7, v1
    v_and_b32 v25, 8, v25
    v_or_b32 v24, v24, v25
    v_lshlrev_b32 v18, 2, v24
    s_waitcnt vmcnt(8) lgkmcnt(0)
    s_barrier
    v_mfma_f32_32x32x16_bf16 v[32:47], a[200:203], a[192:195], v[32:47]
    ds_read_b128 a[16:19], v22
    ds_read_b128 a[20:23], v22 offset:1024
    ds_read_b128 a[32:35], v22 offset:2048
    ds_read_b128 a[36:39], v22 offset:3072
    v_mfma_f32_32x32x16_bf16 v[32:47], a[216:219], a[208:211], v[32:47]
    v_lshlrev_b32 v24, 2, v3
    s_lshl_b32 s50, s29, 9
    s_lshl_b32 s51, s22, 8
    s_add_u32 s50, s50, s51
    v_mfma_f32_32x32x16_bf16 v[32:47], a[232:235], a[224:227], v[32:47]
    s_add_u32 s50, s50, 524288
    buffer_load_dword v26, v24, s[16:19], s50 offen sc1
    buffer_load_dword v27, v24, s[16:19], s50 offen offset:128 sc1
    s_add_u32 m0, s36, 0x10000
    v_mfma_f32_32x32x16_bf16 v[32:47], a[248:251], a[240:243], v[32:47]
    s_mov_b32 s32, 0x10000
    buffer_load_dwordx4 v8, s[44:47], s32 offen offset:0 sc1 lds
    buffer_load_dwordx4 v9, s[44:47], s32 offen offset:1024 sc1 lds
    buffer_load_dwordx4 v10, s[44:47], s32 offen offset:2048 sc1 lds
    v_mfma_f32_32x32x16_bf16 v[48:63], a[200:203], a[196:199], v[48:63]
    buffer_load_dwordx4 v11, s[44:47], s32 offen offset:3072 sc1 lds
    s_mov_b32 s37, 0x18000
    s_mov_b32 s39, 0
    s_mov_b32 s71, 0
    v_mfma_f32_32x32x16_bf16 v[48:63], a[216:219], a[212:215], v[48:63]
    s_mov_b32 s33, 0x4000
    v_mfma_f32_32x32x16_bf16 v[48:63], a[232:235], a[228:231], v[48:63]
    s_mov_b32 s38, -1
    v_mfma_f32_32x32x16_bf16 v[48:63], a[248:251], a[244:247], v[48:63]
    v_cvt_pk_bf16_f32 v224, v32, v33
    v_cvt_pk_bf16_f32 v225, v34, v35
    v_cvt_pk_bf16_f32 v226, v36, v37
    v_cvt_pk_bf16_f32 v227, v38, v39
    v_cvt_pk_bf16_f32 v228, v40, v41
    v_mfma_f32_32x32x16_bf16 v[64:79], a[204:207], a[192:195], v[64:79]
    v_cvt_pk_bf16_f32 v229, v42, v43
    v_cvt_pk_bf16_f32 v230, v44, v45
    v_cvt_pk_bf16_f32 v231, v46, v47
    s_waitcnt lgkmcnt(0)
    v_mfma_f32_32x32x16_bf16 v[64:79], a[220:223], a[208:211], v[64:79]
    v_mfma_f32_32x32x16_bf16 v[32:47], a[16:19], v[224:227], 0
    v_mfma_f32_32x32x16_bf16 v[32:47], a[20:23], v[228:231], v[32:47]
    v_mfma_f32_32x32x16_bf16 v[64:79], a[236:239], a[224:227], v[64:79]
    v_cvt_pk_bf16_f32 v232, v48, v49
    v_cvt_pk_bf16_f32 v233, v50, v51
    v_cvt_pk_bf16_f32 v234, v52, v53
    v_cvt_pk_bf16_f32 v235, v54, v55
    v_cvt_pk_bf16_f32 v236, v56, v57
    v_mfma_f32_32x32x16_bf16 v[64:79], a[252:255], a[240:243], v[64:79]
    v_cvt_pk_bf16_f32 v237, v58, v59
    v_cvt_pk_bf16_f32 v238, v60, v61
    v_cvt_pk_bf16_f32 v239, v62, v63
    v_mfma_f32_32x32x16_bf16 v[80:95], a[204:207], a[196:199], v[80:95]
    v_mfma_f32_32x32x16_bf16 v[48:63], a[16:19], v[232:235], 0
    v_mfma_f32_32x32x16_bf16 v[48:63], a[20:23], v[236:239], v[48:63]
    v_mfma_f32_32x32x16_bf16 v[80:95], a[220:223], a[212:215], v[80:95]
    v_max3_f32 v32, v32, v33, v34
    v_max3_f32 v32, v32, v35, v36
    v_max3_f32 v32, v32, v37, v38
    v_max3_f32 v32, v32, v39, v40
    v_max3_f32 v32, v32, v41, v42
    v_mfma_f32_32x32x16_bf16 v[80:95], a[236:239], a[228:231], v[80:95]
    v_max3_f32 v32, v32, v43, v44
    v_max3_f32 v32, v32, v45, v46
    v_max_f32 v32, v32, v47
    v_mfma_f32_32x32x16_bf16 v[80:95], a[252:255], a[244:247], v[80:95]
    v_mov_b32 v33, v32
    s_nop 1
    v_permlane32_swap_b32 v32, v33
    s_nop 1
    v_cvt_pk_bf16_f32 v240, v64, v65
    v_cvt_pk_bf16_f32 v241, v66, v67
    v_cvt_pk_bf16_f32 v242, v68, v69
    v_cvt_pk_bf16_f32 v243, v70, v71
    v_cvt_pk_bf16_f32 v244, v72, v73
    v_cvt_pk_bf16_f32 v245, v74, v75
    v_cvt_pk_bf16_f32 v246, v76, v77
    v_cvt_pk_bf16_f32 v247, v78, v79
    v_max_f32 v32, v32, v33
    v_sub_f32 v96, 0, v32
    v_sub_f32 v97, 0, v32
    v_mfma_f32_32x32x16_bf16 v[64:79], a[16:19], v[240:243], 0
    v_mov_b64 v[98:99], v[96:97]
    v_mov_b64 v[100:101], v[96:97]
    v_mov_b64 v[102:103], v[96:97]
    v_mov_b64 v[104:105], v[96:97]
    v_mfma_f32_32x32x16_bf16 v[64:79], a[20:23], v[244:247], v[64:79]
    v_mov_b64 v[106:107], v[96:97]
    v_mov_b64 v[108:109], v[96:97]
    v_mov_b64 v[110:111], v[96:97]
    v_cvt_pk_bf16_f32 v248, v80, v81
    v_cvt_pk_bf16_f32 v249, v82, v83
    v_cvt_pk_bf16_f32 v250, v84, v85
    v_cvt_pk_bf16_f32 v251, v86, v87
    v_cvt_pk_bf16_f32 v252, v88, v89
    v_cvt_pk_bf16_f32 v253, v90, v91
    v_cvt_pk_bf16_f32 v254, v92, v93
    v_cvt_pk_bf16_f32 v255, v94, v95
    v_max3_f32 v48, v48, v49, v50
    v_max3_f32 v48, v48, v51, v52
    v_mfma_f32_32x32x16_bf16 v[80:95], a[16:19], v[248:251], 0
    v_max3_f32 v48, v48, v53, v54
    v_max3_f32 v48, v48, v55, v56
    v_max3_f32 v48, v48, v57, v58
    v_max3_f32 v48, v48, v59, v60
    v_mfma_f32_32x32x16_bf16 v[80:95], a[20:23], v[252:255], v[80:95]
    v_max3_f32 v48, v48, v61, v62
    v_max_f32 v48, v48, v63
    v_mov_b32 v49, v48
    s_nop 1
    v_permlane32_swap_b32 v48, v49
    v_mfma_f32_32x32x16_bf16 v[32:47], a[16:19], v[224:227], v[96:111]
    s_nop 1
    v_max_f32 v48, v48, v49
    v_sub_f32 v112, 0, v48
    v_sub_f32 v113, 0, v48
    v_mov_b64 v[114:115], v[112:113]
    v_mfma_f32_32x32x16_bf16 v[32:47], a[20:23], v[228:231], v[32:47]
    v_mov_b64 v[116:117], v[112:113]
    v_mov_b64 v[118:119], v[112:113]
    v_mov_b64 v[120:121], v[112:113]
    v_mov_b64 v[122:123], v[112:113]
    v_mov_b64 v[124:125], v[112:113]
    v_mov_b64 v[126:127], v[112:113]
    v_max3_f32 v64, v64, v65, v66
    v_max3_f32 v64, v64, v67, v68
    v_max3_f32 v64, v64, v69, v70
    v_max3_f32 v64, v64, v71, v72
    v_max3_f32 v64, v64, v73, v74
    v_max3_f32 v64, v64, v75, v76
    v_max3_f32 v64, v64, v77, v78
    v_max_f32 v64, v64, v79
    v_mov_b32 v65, v64
    s_nop 1
    v_permlane32_swap_b32 v64, v65
    s_nop 1
    v_max_f32 v64, v64, v65
    v_sub_f32 v128, 0, v64
    v_sub_f32 v129, 0, v64
    v_mov_b64 v[130:131], v[128:129]
    v_mov_b64 v[132:133], v[128:129]
    v_mov_b64 v[134:135], v[128:129]
    v_mov_b64 v[136:137], v[128:129]
    v_mov_b64 v[138:139], v[128:129]
    v_mov_b64 v[140:141], v[128:129]
    v_mov_b64 v[142:143], v[128:129]
    v_max3_f32 v80, v80, v81, v82
    v_max3_f32 v80, v80, v83, v84
    v_max3_f32 v80, v80, v85, v86
    v_max3_f32 v80, v80, v87, v88
    v_max3_f32 v80, v80, v89, v90
    v_max3_f32 v80, v80, v91, v92
    v_max3_f32 v80, v80, v93, v94
    v_max_f32 v80, v80, v95
    v_mov_b32 v81, v80
    s_nop 1
    v_permlane32_swap_b32 v80, v81
    s_nop 1
    v_max_f32 v80, v80, v81
    v_sub_f32 v144, 0, v80
    v_sub_f32 v145, 0, v80
    v_mov_b64 v[146:147], v[144:145]
    v_mov_b64 v[148:149], v[144:145]
    v_mov_b64 v[150:151], v[144:145]
    v_mov_b64 v[152:153], v[144:145]
    v_mov_b64 v[154:155], v[144:145]
    v_mov_b64 v[156:157], v[144:145]
    v_mov_b64 v[158:159], v[144:145]
    v_mov_b64 v[80:81], 0
    v_mov_b64 v[82:83], 0
    v_mov_b64 v[84:85], 0
    v_mov_b64 v[86:87], 0
    v_mov_b64 v[88:89], 0
    v_mov_b64 v[90:91], 0
    v_mov_b64 v[92:93], 0
    v_mov_b64 v[94:95], 0
    s_waitcnt vmcnt(6)
    s_barrier
    s_branch L_at_pre_entry
L_at_switch:
    v_mov_b32 v8, v12
    v_mov_b32 v9, v13
    v_mov_b32 v10, v14
    v_mov_b32 v11, v15
    s_mov_b32 s44, s72
    s_mov_b32 s45, s73
    s_mov_b32 s46, 0x200000
    s_lshl_b32 s32, s30, 18
    s_mov_b32 s33, 0x40000
    s_mov_b32 s38, 0x1fffff
    s_branch L_at_top_bar
.p2align 6
L_at_top_bar:
    s_waitcnt vmcnt(2)
    s_barrier
L_at_top:
    v_add_u32 v22, s71, v28
    v_exp_f32 v41, v41
    v_exp_f32 v42, v42
    v_exp_f32 v43, v43
    v_smfmac_f32_16x16x64_bf16 a[12:15], a[48:51], v[80:87], v23
    ds_read_b128 a[16:19], v22 offset:0
    v_exp_f32 v44, v44
    v_exp_f32 v45, v45
    v_smfmac_f32_16x16x64_bf16 a[12:15], a[48:51], v[88:95], v23
    ds_read_b128 a[20:23], v22 offset:1024
    v_exp_f32 v46, v46
    v_exp_f32 v47, v47
    v_mfma_f32_32x32x16_bf16 v[64:79], a[24:27], v[240:243], v[128:143]
    v_exp_f32 v48, v48
    v_exp_f32 v49, v49
    v_exp_f32 v50, v50
    v_smfmac_f32_32x32x32_bf16 v[160:175], a[40:43], v[32:39], v23
    s_add_u32 m0, s37, s36
    s_add_u32 s37, s37, 0x8000
    v_exp_f32 v51, v51
    v_exp_f32 v52, v52
    v_exp_f32 v53, v53
    v_mfma_f32_32x32x16_bf16 v[64:79], a[28:31], v[244:247], v[64:79]
    v_exp_f32 v54, v54
    v_exp_f32 v55, v55
    v_exp_f32 v56, v56
    v_smfmac_f32_32x32x32_bf16 v[160:175], a[44:47], v[40:47], v23
    s_and_b32 s37, s37, 0x1ffff
    v_exp_f32 v57, v57
    v_exp_f32 v58, v58
    v_exp_f32 v59, v59
    v_smfmac_f32_16x16x64_bf16 a[0:3], a[48:51], v[32:39], v23
    buffer_load_dwordx4 v8, s[44:47], s32 offen offset:0 sc1 lds
    v_exp_f32 v60, v60
    v_exp_f32 v61, v61
    v_smfmac_f32_16x16x64_bf16 a[0:3], a[48:51], v[40:47], v23
    buffer_load_dwordx4 v9, s[44:47], s32 offen offset:1024 sc1 lds
    v_exp_f32 v62, v62
    v_exp_f32 v63, v63
    v_mfma_f32_32x32x16_bf16 v[80:95], a[24:27], v[248:251], v[144:159]
    v_exp_f32 v64, v64
    v_exp_f32 v65, v65
    v_exp_f32 v66, v66
    v_smfmac_f32_32x32x32_bf16 v[176:191], a[40:43], v[48:55], v23
    v_exp_f32 v67, v67
    v_exp_f32 v68, v68
    v_exp_f32 v69, v69
    v_mfma_f32_32x32x16_bf16 v[80:95], a[28:31], v[252:255], v[80:95]
    v_exp_f32 v70, v70
    v_exp_f32 v71, v71
    v_exp_f32 v72, v72
    v_smfmac_f32_32x32x32_bf16 v[176:191], a[44:47], v[56:63], v23
    s_waitcnt lgkmcnt(0)
    v_exp_f32 v73, v73
    v_exp_f32 v74, v74
    v_exp_f32 v75, v75
    v_smfmac_f32_16x16x64_bf16 a[4:7], a[48:51], v[48:55], v23
    ds_read_b128 a[32:35], v22 offset:2048
    v_exp_f32 v76, v76
    v_exp_f32 v77, v77
    v_smfmac_f32_16x16x64_bf16 a[4:7], a[48:51], v[56:63], v23
    ds_read_b128 a[36:39], v22 offset:3072
    v_exp_f32 v78, v78
    v_exp_f32 v79, v79
    v_mfma_f32_32x32x16_bf16 v[32:47], a[16:19], v[224:227], v[96:111]
    v_exp_f32 v80, v80
    v_exp_f32 v81, v81
    v_exp_f32 v82, v82
    v_smfmac_f32_32x32x32_bf16 v[192:207], a[40:43], v[64:71], v23
    v_exp_f32 v83, v83
    v_exp_f32 v84, v84
    v_exp_f32 v85, v85
    v_mfma_f32_32x32x16_bf16 v[32:47], a[20:23], v[228:231], v[32:47]
    v_exp_f32 v86, v86
    v_exp_f32 v87, v87
    v_exp_f32 v88, v88
    v_smfmac_f32_32x32x32_bf16 v[192:207], a[44:47], v[72:79], v23
    v_exp_f32 v89, v89
    v_exp_f32 v90, v90
    v_exp_f32 v91, v91
    v_smfmac_f32_16x16x64_bf16 a[8:11], a[48:51], v[64:71], v23
    buffer_load_dwordx4 v10, s[44:47], s32 offen offset:2048 sc1 lds
    v_exp_f32 v92, v92
    v_exp_f32 v93, v93
    v_smfmac_f32_16x16x64_bf16 a[8:11], a[48:51], v[72:79], v23
    buffer_load_dwordx4 v11, s[44:47], s32 offen offset:3072 sc1 lds
    v_exp_f32 v94, v94
    v_exp_f32 v95, v95
L_at_pre_entry:
    v_mfma_f32_32x32x16_bf16 v[48:63], a[16:19], v[232:235], v[112:127]
    s_add_u32 m0, m0, 0x4000
    v_exp_f32 v32, v32
    v_exp_f32 v33, v33
    v_exp_f32 v34, v34
    v_smfmac_f32_32x32x32_bf16 v[208:223], a[40:43], v[80:87], v23
    s_add_u32 s32, s32, s33
    s_and_b32 s32, s32, s38
    v_exp_f32 v35, v35
    v_exp_f32 v36, v36
    v_exp_f32 v37, v37
    v_mfma_f32_32x32x16_bf16 v[48:63], a[20:23], v[236:239], v[48:63]
    v_exp_f32 v38, v38
    v_exp_f32 v39, v39
    v_exp_f32 v40, v40
    v_smfmac_f32_32x32x32_bf16 v[208:223], a[44:47], v[88:95], v23
    s_waitcnt lgkmcnt(0)
    v_exp_f32 v41, v41
    v_exp_f32 v42, v42
    v_exp_f32 v43, v43
    v_smfmac_f32_16x16x64_bf16 a[12:15], a[48:51], v[80:87], v23
    ds_read_b128 a[24:27], v22 offset:4096
    v_exp_f32 v44, v44
    v_exp_f32 v45, v45
    v_smfmac_f32_16x16x64_bf16 a[12:15], a[48:51], v[88:95], v23
    ds_read_b128 a[28:31], v22 offset:5120
    v_exp_f32 v46, v46
    v_exp_f32 v47, v47
    v_mfma_f32_32x32x16_bf16 v[64:79], a[16:19], v[240:243], v[128:143]
    v_exp_f32 v48, v48
    v_exp_f32 v49, v49
    v_exp_f32 v50, v50
    v_smfmac_f32_32x32x32_bf16 v[160:175], a[32:35], v[32:39], v23
    v_exp_f32 v51, v51
    v_exp_f32 v52, v52
    v_exp_f32 v53, v53
    v_mfma_f32_32x32x16_bf16 v[64:79], a[20:23], v[244:247], v[64:79]
    v_exp_f32 v54, v54
    v_exp_f32 v55, v55
    v_exp_f32 v56, v56
    v_smfmac_f32_32x32x32_bf16 v[160:175], a[36:39], v[40:47], v23
    v_exp_f32 v57, v57
    v_exp_f32 v58, v58
    v_exp_f32 v59, v59
    v_smfmac_f32_16x16x64_bf16 a[0:3], a[48:51], v[32:39], v23
    buffer_load_dwordx4 v8, s[44:47], s32 offen offset:0 sc1 lds
    v_exp_f32 v60, v60
    v_exp_f32 v61, v61
    v_smfmac_f32_16x16x64_bf16 a[0:3], a[48:51], v[40:47], v23
    buffer_load_dwordx4 v9, s[44:47], s32 offen offset:1024 sc1 lds
    v_exp_f32 v62, v62
    v_exp_f32 v63, v63
    v_mfma_f32_32x32x16_bf16 v[80:95], a[16:19], v[248:251], v[144:159]
    v_exp_f32 v64, v64
    v_exp_f32 v65, v65
    v_exp_f32 v66, v66
    v_smfmac_f32_32x32x32_bf16 v[176:191], a[32:35], v[48:55], v23
    v_exp_f32 v67, v67
    v_exp_f32 v68, v68
    v_exp_f32 v69, v69
    v_mfma_f32_32x32x16_bf16 v[80:95], a[20:23], v[252:255], v[80:95]
    v_exp_f32 v70, v70
    v_exp_f32 v71, v71
    v_exp_f32 v72, v72
    v_smfmac_f32_32x32x32_bf16 v[176:191], a[36:39], v[56:63], v23
    s_waitcnt lgkmcnt(0)
    v_exp_f32 v73, v73
    v_exp_f32 v74, v74
    v_exp_f32 v75, v75
    v_smfmac_f32_16x16x64_bf16 a[4:7], a[48:51], v[48:55], v23
    ds_read_b128 a[40:43], v22 offset:6144
    v_exp_f32 v76, v76
    v_exp_f32 v77, v77
    v_smfmac_f32_16x16x64_bf16 a[4:7], a[48:51], v[56:63], v23
    ds_read_b128 a[44:47], v22 offset:7168
    v_exp_f32 v78, v78
    v_exp_f32 v79, v79
    v_mfma_f32_32x32x16_bf16 v[32:47], a[24:27], v[224:227], v[96:111]
    v_exp_f32 v80, v80
    v_exp_f32 v81, v81
    v_exp_f32 v82, v82
    v_smfmac_f32_32x32x32_bf16 v[192:207], a[32:35], v[64:71], v23
    v_exp_f32 v83, v83
    v_exp_f32 v84, v84
    v_exp_f32 v85, v85
    v_mfma_f32_32x32x16_bf16 v[32:47], a[28:31], v[228:231], v[32:47]
    v_exp_f32 v86, v86
    v_exp_f32 v87, v87
    v_exp_f32 v88, v88
    v_smfmac_f32_32x32x32_bf16 v[192:207], a[36:39], v[72:79], v23
    v_exp_f32 v89, v89
    v_exp_f32 v90, v90
    v_exp_f32 v91, v91
    v_smfmac_f32_16x16x64_bf16 a[8:11], a[48:51], v[64:71], v23
    buffer_load_dwordx4 v10, s[44:47], s32 offen offset:2048 sc1 lds
    v_exp_f32 v92, v92
    v_exp_f32 v93, v93
    v_smfmac_f32_16x16x64_bf16 a[8:11], a[48:51], v[72:79], v23
    buffer_load_dwordx4 v11, s[44:47], s32 offen offset:3072 sc1 lds
    v_exp_f32 v94, v94
    v_exp_f32 v95, v95
    v_mfma_f32_32x32x16_bf16 v[48:63], a[24:27], v[232:235], v[112:127]
    v_exp_f32 v32, v32
    v_exp_f32 v33, v33
    v_exp_f32 v34, v34
    v_smfmac_f32_32x32x32_bf16 v[208:223], a[32:35], v[80:87], v23
    v_exp_f32 v35, v35
    v_exp_f32 v36, v36
    v_exp_f32 v37, v37
    v_mfma_f32_32x32x16_bf16 v[48:63], a[28:31], v[236:239], v[48:63]
    v_exp_f32 v38, v38
    v_exp_f32 v39, v39
    v_exp_f32 v40, v40
    v_smfmac_f32_32x32x32_bf16 v[208:223], a[36:39], v[88:95], v23
    s_waitcnt lgkmcnt(0)
    v_exp_f32 v41, v41
    v_exp_f32 v42, v42
    v_exp_f32 v43, v43
    v_smfmac_f32_16x16x64_bf16 a[12:15], a[48:51], v[80:87], v23
    ds_read_b128 a[16:19], v22 offset:8192
    v_exp_f32 v44, v44
    v_exp_f32 v45, v45
    v_smfmac_f32_16x16x64_bf16 a[12:15], a[48:51], v[88:95], v23
    ds_read_b128 a[20:23], v22 offset:9216
    v_exp_f32 v46, v46
    v_exp_f32 v47, v47
    v_mfma_f32_32x32x16_bf16 v[64:79], a[24:27], v[240:243], v[128:143]
    v_exp_f32 v48, v48
    v_exp_f32 v49, v49
    v_exp_f32 v50, v50
    v_smfmac_f32_32x32x32_bf16 v[160:175], a[40:43], v[32:39], v23
    s_add_u32 s32, s32, s33
    s_and_b32 s32, s32, s38
    v_exp_f32 v51, v51
    v_exp_f32 v52, v52
    v_exp_f32 v53, v53
    v_mfma_f32_32x32x16_bf16 v[64:79], a[28:31], v[244:247], v[64:79]
    s_add_u32 m0, s36, 0x20000
    v_exp_f32 v54, v54
    v_exp_f32 v55, v55
    v_exp_f32 v56, v56
    v_smfmac_f32_32x32x32_bf16 v[160:175], a[44:47], v[40:47], v23
    v_exp_f32 v57, v57
    v_exp_f32 v58, v58
    v_exp_f32 v59, v59
    v_smfmac_f32_16x16x64_bf16 a[0:3], a[48:51], v[32:39], v23
    buffer_load_dwordx4 v28, s[52:55], s68 offen lds
    v_exp_f32 v60, v60
    v_exp_f32 v61, v61
    v_smfmac_f32_16x16x64_bf16 a[0:3], a[48:51], v[40:47], v23
    s_add_u32 s68, s68, 0x800
    v_exp_f32 v62, v62
    v_exp_f32 v63, v63
    v_mfma_f32_32x32x16_bf16 v[80:95], a[24:27], v[248:251], v[144:159]
    v_exp_f32 v64, v64
    v_exp_f32 v65, v65
    v_exp_f32 v66, v66
    v_smfmac_f32_32x32x32_bf16 v[176:191], a[40:43], v[48:55], v23
    v_exp_f32 v67, v67
    v_exp_f32 v68, v68
    v_exp_f32 v69, v69
    v_mfma_f32_32x32x16_bf16 v[80:95], a[28:31], v[252:255], v[80:95]
    v_exp_f32 v70, v70
    v_exp_f32 v71, v71
    v_exp_f32 v72, v72
    v_smfmac_f32_32x32x32_bf16 v[176:191], a[44:47], v[56:63], v23
    s_waitcnt lgkmcnt(0)
    v_exp_f32 v73, v73
    v_exp_f32 v74, v74
    v_exp_f32 v75, v75
    v_smfmac_f32_16x16x64_bf16 a[4:7], a[48:51], v[48:55], v23
    ds_read_b128 a[32:35], v22 offset:10240
    v_exp_f32 v76, v76
    v_exp_f32 v77, v77
    v_smfmac_f32_16x16x64_bf16 a[4:7], a[48:51], v[56:63], v23
    ds_read_b128 a[36:39], v22 offset:11264
    v_exp_f32 v78, v78
    v_exp_f32 v79, v79
    v_mfma_f32_32x32x16_bf16 v[32:47], a[16:19], v[224:227], v[96:111]
    v_exp_f32 v80, v80
    v_exp_f32 v81, v81
    v_exp_f32 v82, v82
    v_smfmac_f32_32x32x32_bf16 v[192:207], a[40:43], v[64:71], v23
    v_exp_f32 v83, v83
    v_exp_f32 v84, v84
    v_exp_f32 v85, v85
    v_mfma_f32_32x32x16_bf16 v[32:47], a[20:23], v[228:231], v[32:47]
    v_exp_f32 v86, v86
    v_exp_f32 v87, v87
    v_exp_f32 v88, v88
    v_smfmac_f32_32x32x32_bf16 v[192:207], a[44:47], v[72:79], v23
    v_exp_f32 v89, v89
    v_exp_f32 v90, v90
    v_exp_f32 v91, v91
    v_smfmac_f32_16x16x64_bf16 a[8:11], a[48:51], v[64:71], v23
    v_exp_f32 v92, v92
    v_exp_f32 v93, v93
    v_smfmac_f32_16x16x64_bf16 a[8:11], a[48:51], v[72:79], v23
    v_exp_f32 v94, v94
    v_exp_f32 v95, v95
    v_mfma_f32_32x32x16_bf16 v[48:63], a[16:19], v[232:235], v[112:127]
    v_exp_f32 v32, v32
    v_exp_f32 v33, v33
    v_exp_f32 v34, v34
    v_smfmac_f32_32x32x32_bf16 v[208:223], a[40:43], v[80:87], v23
    v_exp_f32 v35, v35
    v_exp_f32 v36, v36
    v_exp_f32 v37, v37
    v_mfma_f32_32x32x16_bf16 v[48:63], a[20:23], v[236:239], v[48:63]
    v_exp_f32 v38, v38
    v_exp_f32 v39, v39
    v_exp_f32 v40, v40
    v_smfmac_f32_32x32x32_bf16 v[208:223], a[44:47], v[88:95], v23
    s_waitcnt lgkmcnt(0)
    v_exp_f32 v41, v41
    v_exp_f32 v42, v42
    v_exp_f32 v43, v43
    v_smfmac_f32_16x16x64_bf16 a[12:15], a[48:51], v[80:87], v23
    ds_read_b128 a[24:27], v22 offset:12288
    v_exp_f32 v44, v44
    v_exp_f32 v45, v45
    v_smfmac_f32_16x16x64_bf16 a[12:15], a[48:51], v[88:95], v23
    ds_read_b128 a[28:31], v22 offset:13312
    v_exp_f32 v46, v46
    v_exp_f32 v47, v47
    v_mfma_f32_32x32x16_bf16 v[64:79], a[16:19], v[240:243], v[128:143]
    v_exp_f32 v48, v48
    v_exp_f32 v49, v49
    v_exp_f32 v50, v50
    v_smfmac_f32_32x32x32_bf16 v[160:175], a[32:35], v[32:39], v23
    v_exp_f32 v51, v51
    v_exp_f32 v52, v52
    v_exp_f32 v53, v53
    v_mfma_f32_32x32x16_bf16 v[64:79], a[20:23], v[244:247], v[64:79]
    v_exp_f32 v54, v54
    v_exp_f32 v55, v55
    v_exp_f32 v56, v56
    v_smfmac_f32_32x32x32_bf16 v[160:175], a[36:39], v[40:47], v23
    v_exp_f32 v57, v57
    v_exp_f32 v58, v58
    v_exp_f32 v59, v59
    v_smfmac_f32_16x16x64_bf16 a[0:3], a[48:51], v[32:39], v23
    v_exp_f32 v60, v60
    v_exp_f32 v61, v61
    v_smfmac_f32_16x16x64_bf16 a[0:3], a[48:51], v[40:47], v23
    v_exp_f32 v62, v62
    v_exp_f32 v63, v63
    v_mfma_f32_32x32x16_bf16 v[80:95], a[16:19], v[248:251], v[144:159]
    v_exp_f32 v64, v64
    v_exp_f32 v65, v65
    v_exp_f32 v66, v66
    v_smfmac_f32_32x32x32_bf16 v[176:191], a[32:35], v[48:55], v23
    v_exp_f32 v67, v67
    v_exp_f32 v68, v68
    v_exp_f32 v69, v69
    v_mfma_f32_32x32x16_bf16 v[80:95], a[20:23], v[252:255], v[80:95]
    v_exp_f32 v70, v70
    v_exp_f32 v71, v71
    v_exp_f32 v72, v72
    v_smfmac_f32_32x32x32_bf16 v[176:191], a[36:39], v[56:63], v23
    s_waitcnt lgkmcnt(0)
    v_exp_f32 v73, v73
    v_exp_f32 v74, v74
    v_exp_f32 v75, v75
    v_smfmac_f32_16x16x64_bf16 a[4:7], a[48:51], v[48:55], v23
    ds_read_b128 a[40:43], v22 offset:14336
    v_exp_f32 v76, v76
    v_exp_f32 v77, v77
    v_smfmac_f32_16x16x64_bf16 a[4:7], a[48:51], v[56:63], v23
    ds_read_b128 a[44:47], v22 offset:15360
    v_exp_f32 v78, v78
    v_exp_f32 v79, v79
    v_mfma_f32_32x32x16_bf16 v[32:47], a[24:27], v[224:227], v[96:111]
    v_exp_f32 v80, v80
    v_exp_f32 v81, v81
    v_exp_f32 v82, v82
    v_smfmac_f32_32x32x32_bf16 v[192:207], a[32:35], v[64:71], v23
    v_exp_f32 v83, v83
    v_exp_f32 v84, v84
    v_exp_f32 v85, v85
    v_mfma_f32_32x32x16_bf16 v[32:47], a[28:31], v[228:231], v[32:47]
    v_exp_f32 v86, v86
    v_exp_f32 v87, v87
    v_exp_f32 v88, v88
    v_smfmac_f32_32x32x32_bf16 v[192:207], a[36:39], v[72:79], v23
    v_exp_f32 v89, v89
    v_exp_f32 v90, v90
    v_exp_f32 v91, v91
    v_smfmac_f32_16x16x64_bf16 a[8:11], a[48:51], v[64:71], v23
    v_exp_f32 v92, v92
    v_exp_f32 v93, v93
    v_smfmac_f32_16x16x64_bf16 a[8:11], a[48:51], v[72:79], v23
    v_exp_f32 v94, v94
    v_exp_f32 v95, v95
    v_mfma_f32_32x32x16_bf16 v[48:63], a[24:27], v[232:235], v[112:127]
    v_exp_f32 v32, v32
    v_exp_f32 v33, v33
    v_exp_f32 v34, v34
    v_smfmac_f32_32x32x32_bf16 v[208:223], a[32:35], v[80:87], v23
    v_exp_f32 v35, v35
    v_exp_f32 v36, v36
    v_exp_f32 v37, v37
    v_mfma_f32_32x32x16_bf16 v[48:63], a[28:31], v[236:239], v[48:63]
    v_exp_f32 v38, v38
    v_exp_f32 v39, v39
    v_exp_f32 v40, v40
    v_smfmac_f32_32x32x32_bf16 v[208:223], a[36:39], v[88:95], v23
    s_waitcnt lgkmcnt(0)
    v_exp_f32 v41, v41
    v_exp_f32 v42, v42
    v_exp_f32 v43, v43
    v_smfmac_f32_16x16x64_bf16 a[12:15], a[48:51], v[80:87], v23
    ds_read_b128 a[16:19], v22 offset:16384
    v_exp_f32 v44, v44
    v_exp_f32 v45, v45
    v_smfmac_f32_16x16x64_bf16 a[12:15], a[48:51], v[88:95], v23
    ds_read_b128 a[20:23], v22 offset:17408
    v_exp_f32 v46, v46
    v_exp_f32 v47, v47
    v_mfma_f32_32x32x16_bf16 v[64:79], a[24:27], v[240:243], v[128:143]
    v_exp_f32 v48, v48
    v_exp_f32 v49, v49
    v_exp_f32 v50, v50
    v_smfmac_f32_32x32x32_bf16 v[160:175], a[40:43], v[32:39], v23
    v_exp_f32 v51, v51
    v_exp_f32 v52, v52
    v_exp_f32 v53, v53
    v_mfma_f32_32x32x16_bf16 v[64:79], a[28:31], v[244:247], v[64:79]
    s_add_u32 m0, s36, 0x20000
    v_exp_f32 v54, v54
    v_exp_f32 v55, v55
    v_exp_f32 v56, v56
    v_smfmac_f32_32x32x32_bf16 v[160:175], a[44:47], v[40:47], v23
    v_exp_f32 v57, v57
    v_exp_f32 v58, v58
    v_exp_f32 v59, v59
    v_smfmac_f32_16x16x64_bf16 a[0:3], a[48:51], v[32:39], v23
    buffer_load_dwordx4 v28, s[52:55], s68 offen lds
    v_exp_f32 v60, v60
    v_exp_f32 v61, v61
    v_smfmac_f32_16x16x64_bf16 a[0:3], a[48:51], v[40:47], v23
    s_add_u32 s68, s68, 0x800
    v_exp_f32 v62, v62
    v_exp_f32 v63, v63
    v_mfma_f32_32x32x16_bf16 v[80:95], a[24:27], v[248:251], v[144:159]
    v_exp_f32 v64, v64
    v_exp_f32 v65, v65
    v_exp_f32 v66, v66
    v_smfmac_f32_32x32x32_bf16 v[176:191], a[40:43], v[48:55], v23
    v_exp_f32 v67, v67
    v_exp_f32 v68, v68
    v_exp_f32 v69, v69
    v_mfma_f32_32x32x16_bf16 v[80:95], a[28:31], v[252:255], v[80:95]
    v_exp_f32 v70, v70
    v_exp_f32 v71, v71
    v_exp_f32 v72, v72
    v_smfmac_f32_32x32x32_bf16 v[176:191], a[44:47], v[56:63], v23
    s_waitcnt lgkmcnt(0)
    v_exp_f32 v73, v73
    v_exp_f32 v74, v74
    v_exp_f32 v75, v75
    v_smfmac_f32_16x16x64_bf16 a[4:7], a[48:51], v[48:55], v23
    ds_read_b128 a[32:35], v22 offset:18432
    v_exp_f32 v76, v76
    v_exp_f32 v77, v77
    v_smfmac_f32_16x16x64_bf16 a[4:7], a[48:51], v[56:63], v23
    ds_read_b128 a[36:39], v22 offset:19456
    v_exp_f32 v78, v78
    v_exp_f32 v79, v79
    v_mfma_f32_32x32x16_bf16 v[32:47], a[16:19], v[224:227], v[96:111]
    v_exp_f32 v80, v80
    v_exp_f32 v81, v81
    v_exp_f32 v82, v82
    v_smfmac_f32_32x32x32_bf16 v[192:207], a[40:43], v[64:71], v23
    v_exp_f32 v83, v83
    v_exp_f32 v84, v84
    v_exp_f32 v85, v85
    v_mfma_f32_32x32x16_bf16 v[32:47], a[20:23], v[228:231], v[32:47]
    v_exp_f32 v86, v86
    v_exp_f32 v87, v87
    v_exp_f32 v88, v88
    v_smfmac_f32_32x32x32_bf16 v[192:207], a[44:47], v[72:79], v23
    s_cmp_eq_u32 s39, 7
    v_exp_f32 v89, v89
    v_exp_f32 v90, v90
    v_exp_f32 v91, v91
    v_smfmac_f32_16x16x64_bf16 a[8:11], a[48:51], v[64:71], v23
    v_exp_f32 v92, v92
    v_exp_f32 v93, v93
    v_smfmac_f32_16x16x64_bf16 a[8:11], a[48:51], v[72:79], v23
    s_cbranch_scc1 L_at_exit
    v_exp_f32 v94, v94
    v_exp_f32 v95, v95
    v_mfma_f32_32x32x16_bf16 v[48:63], a[16:19], v[232:235], v[112:127]
    v_exp_f32 v32, v32
    v_exp_f32 v33, v33
    v_exp_f32 v34, v34
    v_smfmac_f32_32x32x32_bf16 v[208:223], a[40:43], v[80:87], v23
    v_exp_f32 v35, v35
    v_exp_f32 v36, v36
    v_exp_f32 v37, v37
    v_mfma_f32_32x32x16_bf16 v[48:63], a[20:23], v[236:239], v[48:63]
    v_exp_f32 v38, v38
    v_exp_f32 v39, v39
    v_exp_f32 v40, v40
    v_smfmac_f32_32x32x32_bf16 v[208:223], a[44:47], v[88:95], v23
    s_waitcnt lgkmcnt(0)
    v_exp_f32 v41, v41
    v_exp_f32 v42, v42
    v_exp_f32 v43, v43
    v_smfmac_f32_16x16x64_bf16 a[12:15], a[48:51], v[80:87], v23
    ds_read_b128 a[24:27], v22 offset:20480
    v_exp_f32 v44, v44
    v_exp_f32 v45, v45
    v_smfmac_f32_16x16x64_bf16 a[12:15], a[48:51], v[88:95], v23
    ds_read_b128 a[28:31], v22 offset:21504
    v_exp_f32 v46, v46
    v_exp_f32 v47, v47
    v_mfma_f32_32x32x16_bf16 v[64:79], a[16:19], v[240:243], v[128:143]
    v_exp_f32 v48, v48
    v_exp_f32 v49, v49
    v_exp_f32 v50, v50
    v_smfmac_f32_32x32x32_bf16 v[160:175], a[32:35], v[32:39], v23
    v_exp_f32 v51, v51
    v_exp_f32 v52, v52
    v_exp_f32 v53, v53
    v_mfma_f32_32x32x16_bf16 v[64:79], a[20:23], v[244:247], v[64:79]
    v_exp_f32 v54, v54
    v_exp_f32 v55, v55
    v_exp_f32 v56, v56
    v_smfmac_f32_32x32x32_bf16 v[160:175], a[36:39], v[40:47], v23
    v_exp_f32 v57, v57
    v_exp_f32 v58, v58
    v_exp_f32 v59, v59
    v_smfmac_f32_16x16x64_bf16 a[0:3], a[48:51], v[32:39], v23
    v_exp_f32 v60, v60
    v_exp_f32 v61, v61
    v_smfmac_f32_16x16x64_bf16 a[0:3], a[48:51], v[40:47], v23
    v_exp_f32 v62, v62
    v_exp_f32 v63, v63
    v_mfma_f32_32x32x16_bf16 v[80:95], a[16:19], v[248:251], v[144:159]
    v_exp_f32 v64, v64
    v_exp_f32 v65, v65
    v_exp_f32 v66, v66
    v_smfmac_f32_32x32x32_bf16 v[176:191], a[32:35], v[48:55], v23
    v_exp_f32 v67, v67
    v_exp_f32 v68, v68
    v_exp_f32 v69, v69
    v_mfma_f32_32x32x16_bf16 v[80:95], a[20:23], v[252:255], v[80:95]
    v_exp_f32 v70, v70
    v_exp_f32 v71, v71
    v_exp_f32 v72, v72
    v_smfmac_f32_32x32x32_bf16 v[176:191], a[36:39], v[56:63], v23
    s_waitcnt lgkmcnt(0)
    v_exp_f32 v73, v73
    v_exp_f32 v74, v74
    v_exp_f32 v75, v75
    v_smfmac_f32_16x16x64_bf16 a[4:7], a[48:51], v[48:55], v23
    ds_read_b128 a[40:43], v22 offset:22528
    v_exp_f32 v76, v76
    v_exp_f32 v77, v77
    v_smfmac_f32_16x16x64_bf16 a[4:7], a[48:51], v[56:63], v23
    ds_read_b128 a[44:47], v22 offset:23552
    v_exp_f32 v78, v78
    v_exp_f32 v79, v79
    v_mfma_f32_32x32x16_bf16 v[32:47], a[24:27], v[224:227], v[96:111]
    v_exp_f32 v80, v80
    v_exp_f32 v81, v81
    v_exp_f32 v82, v82
    v_smfmac_f32_32x32x32_bf16 v[192:207], a[32:35], v[64:71], v23
    v_exp_f32 v83, v83
    v_exp_f32 v84, v84
    v_exp_f32 v85, v85
    v_mfma_f32_32x32x16_bf16 v[32:47], a[28:31], v[228:231], v[32:47]
    v_exp_f32 v86, v86
    v_exp_f32 v87, v87
    v_exp_f32 v88, v88
    v_smfmac_f32_32x32x32_bf16 v[192:207], a[36:39], v[72:79], v23
    v_exp_f32 v89, v89
    v_exp_f32 v90, v90
    v_exp_f32 v91, v91
    v_smfmac_f32_16x16x64_bf16 a[8:11], a[48:51], v[64:71], v23
    v_exp_f32 v92, v92
    v_exp_f32 v93, v93
    v_smfmac_f32_16x16x64_bf16 a[8:11], a[48:51], v[72:79], v23
    v_exp_f32 v94, v94
    v_exp_f32 v95, v95
    v_mfma_f32_32x32x16_bf16 v[48:63], a[24:27], v[232:235], v[112:127]
    v_exp_f32 v32, v32
    v_exp_f32 v33, v33
    v_exp_f32 v34, v34
    v_smfmac_f32_32x32x32_bf16 v[208:223], a[32:35], v[80:87], v23
    v_exp_f32 v35, v35
    v_exp_f32 v36, v36
    v_exp_f32 v37, v37
    v_mfma_f32_32x32x16_bf16 v[48:63], a[28:31], v[236:239], v[48:63]
    v_exp_f32 v38, v38
    v_exp_f32 v39, v39
    v_exp_f32 v40, v40
    v_smfmac_f32_32x32x32_bf16 v[208:223], a[36:39], v[88:95], v23
    s_waitcnt lgkmcnt(0)
    v_exp_f32 v41, v41
    v_exp_f32 v42, v42
    v_exp_f32 v43, v43
    v_smfmac_f32_16x16x64_bf16 a[12:15], a[48:51], v[80:87], v23
    ds_read_b128 a[16:19], v22 offset:24576
    v_exp_f32 v44, v44
    v_exp_f32 v45, v45
    v_smfmac_f32_16x16x64_bf16 a[12:15], a[48:51], v[88:95], v23
    ds_read_b128 a[20:23], v22 offset:25600
    v_exp_f32 v46, v46
    v_exp_f32 v47, v47
    v_mfma_f32_32x32x16_bf16 v[64:79], a[24:27], v[240:243], v[128:143]
    v_exp_f32 v48, v48
    v_exp_f32 v49, v49
    v_exp_f32 v50, v50
    v_smfmac_f32_32x32x32_bf16 v[160:175], a[40:43], v[32:39], v23
    v_exp_f32 v51, v51
    v_exp_f32 v52, v52
    v_exp_f32 v53, v53
    v_mfma_f32_32x32x16_bf16 v[64:79], a[28:31], v[244:247], v[64:79]
    v_exp_f32 v54, v54
    v_exp_f32 v55, v55
    v_exp_f32 v56, v56
    v_smfmac_f32_32x32x32_bf16 v[160:175], a[44:47], v[40:47], v23
    v_exp_f32 v57, v57
    v_exp_f32 v58, v58
    v_exp_f32 v59, v59
    v_smfmac_f32_16x16x64_bf16 a[0:3], a[48:51], v[32:39], v23
    v_exp_f32 v60, v60
    v_exp_f32 v61, v61
    v_smfmac_f32_16x16x64_bf16 a[0:3], a[48:51], v[40:47], v23
    v_exp_f32 v62, v62
    v_exp_f32 v63, v63
    v_mfma_f32_32x32x16_bf16 v[80:95], a[24:27], v[248:251], v[144:159]
    v_exp_f32 v64, v64
    v_exp_f32 v65, v65
    v_exp_f32 v66, v66
    v_smfmac_f32_32x32x32_bf16 v[176:191], a[40:43], v[48:55], v23
    v_exp_f32 v67, v67
    v_exp_f32 v68, v68
    v_exp_f32 v69, v69
    v_mfma_f32_32x32x16_bf16 v[80:95], a[28:31], v[252:255], v[80:95]
    v_exp_f32 v70, v70
    v_exp_f32 v71, v71
    v_exp_f32 v72, v72
    v_smfmac_f32_32x32x32_bf16 v[176:191], a[44:47], v[56:63], v23
    s_waitcnt lgkmcnt(0)
    v_exp_f32 v73, v73
    v_exp_f32 v74, v74
    v_exp_f32 v75, v75
    v_smfmac_f32_16x16x64_bf16 a[4:7], a[48:51], v[48:55], v23
    ds_read_b128 a[32:35], v22 offset:26624
    v_exp_f32 v76, v76
    v_exp_f32 v77, v77
    v_smfmac_f32_16x16x64_bf16 a[4:7], a[48:51], v[56:63], v23
    ds_read_b128 a[36:39], v22 offset:27648
    v_exp_f32 v78, v78
    v_exp_f32 v79, v79
    v_mfma_f32_32x32x16_bf16 v[32:47], a[16:19], v[224:227], v[96:111]
    v_exp_f32 v80, v80
    v_exp_f32 v81, v81
    v_exp_f32 v82, v82
    v_smfmac_f32_32x32x32_bf16 v[192:207], a[40:43], v[64:71], v23
    v_exp_f32 v83, v83
    v_exp_f32 v84, v84
    v_exp_f32 v85, v85
    v_mfma_f32_32x32x16_bf16 v[32:47], a[20:23], v[228:231], v[32:47]
    v_exp_f32 v86, v86
    v_exp_f32 v87, v87
    v_exp_f32 v88, v88
    v_smfmac_f32_32x32x32_bf16 v[192:207], a[44:47], v[72:79], v23
    v_exp_f32 v89, v89
    v_exp_f32 v90, v90
    v_exp_f32 v91, v91
    v_smfmac_f32_16x16x64_bf16 a[8:11], a[48:51], v[64:71], v23
    v_exp_f32 v92, v92
    v_exp_f32 v93, v93
    v_smfmac_f32_16x16x64_bf16 a[8:11], a[48:51], v[72:79], v23
    v_exp_f32 v94, v94
    v_exp_f32 v95, v95
    v_mfma_f32_32x32x16_bf16 v[48:63], a[16:19], v[232:235], v[112:127]
    v_exp_f32 v32, v32
    v_exp_f32 v33, v33
    v_exp_f32 v34, v34
    v_smfmac_f32_32x32x32_bf16 v[208:223], a[40:43], v[80:87], v23
    v_exp_f32 v35, v35
    v_exp_f32 v36, v36
    v_exp_f32 v37, v37
    v_mfma_f32_32x32x16_bf16 v[48:63], a[20:23], v[236:239], v[48:63]
    v_exp_f32 v38, v38
    v_exp_f32 v39, v39
    v_exp_f32 v40, v40
    v_smfmac_f32_32x32x32_bf16 v[208:223], a[44:47], v[88:95], v23
    s_waitcnt lgkmcnt(0)
    v_exp_f32 v41, v41
    v_exp_f32 v42, v42
    v_exp_f32 v43, v43
    v_smfmac_f32_16x16x64_bf16 a[12:15], a[48:51], v[80:87], v23
    ds_read_b128 a[24:27], v22 offset:28672
    v_exp_f32 v44, v44
    v_exp_f32 v45, v45
    v_smfmac_f32_16x16x64_bf16 a[12:15], a[48:51], v[88:95], v23
    ds_read_b128 a[28:31], v22 offset:29696
    v_exp_f32 v46, v46
    v_exp_f32 v47, v47
    v_mfma_f32_32x32x16_bf16 v[64:79], a[16:19], v[240:243], v[128:143]
    v_exp_f32 v48, v48
    v_exp_f32 v49, v49
    v_exp_f32 v50, v50
    v_smfmac_f32_32x32x32_bf16 v[160:175], a[32:35], v[32:39], v23
    v_exp_f32 v51, v51
    v_exp_f32 v52, v52
    v_exp_f32 v53, v53
    v_mfma_f32_32x32x16_bf16 v[64:79], a[20:23], v[244:247], v[64:79]
    v_exp_f32 v54, v54
    v_exp_f32 v55, v55
    v_exp_f32 v56, v56
    v_smfmac_f32_32x32x32_bf16 v[160:175], a[36:39], v[40:47], v23
    v_exp_f32 v57, v57
    v_exp_f32 v58, v58
    v_exp_f32 v59, v59
    v_smfmac_f32_16x16x64_bf16 a[0:3], a[48:51], v[32:39], v23
    v_exp_f32 v60, v60
    v_exp_f32 v61, v61
    v_smfmac_f32_16x16x64_bf16 a[0:3], a[48:51], v[40:47], v23
    v_exp_f32 v62, v62
    v_exp_f32 v63, v63
    v_mfma_f32_32x32x16_bf16 v[80:95], a[16:19], v[248:251], v[144:159]
    v_exp_f32 v64, v64
    v_exp_f32 v65, v65
    v_exp_f32 v66, v66
    v_smfmac_f32_32x32x32_bf16 v[176:191], a[32:35], v[48:55], v23
    v_exp_f32 v67, v67
    v_exp_f32 v68, v68
    v_exp_f32 v69, v69
    v_mfma_f32_32x32x16_bf16 v[80:95], a[20:23], v[252:255], v[80:95]
    v_exp_f32 v70, v70
    v_exp_f32 v71, v71
    v_exp_f32 v72, v72
    v_smfmac_f32_32x32x32_bf16 v[176:191], a[36:39], v[56:63], v23
    s_waitcnt lgkmcnt(0)
    v_exp_f32 v73, v73
    v_exp_f32 v74, v74
    v_exp_f32 v75, v75
    v_smfmac_f32_16x16x64_bf16 a[4:7], a[48:51], v[48:55], v23
    ds_read_b128 a[40:43], v22 offset:30720
    v_exp_f32 v76, v76
    v_exp_f32 v77, v77
    v_smfmac_f32_16x16x64_bf16 a[4:7], a[48:51], v[56:63], v23
    ds_read_b128 a[44:47], v22 offset:31744
    v_exp_f32 v78, v78
    v_exp_f32 v79, v79
    v_mfma_f32_32x32x16_bf16 v[32:47], a[24:27], v[224:227], v[96:111]
    v_exp_f32 v80, v80
    v_exp_f32 v81, v81
    v_exp_f32 v82, v82
    v_smfmac_f32_32x32x32_bf16 v[192:207], a[32:35], v[64:71], v23
    s_cmp_eq_u32 s39, 5
    s_cselect_b64 vcc, -1, 0
    v_exp_f32 v83, v83
    v_exp_f32 v84, v84
    v_exp_f32 v85, v85
    v_mfma_f32_32x32x16_bf16 v[32:47], a[28:31], v[228:231], v[32:47]
    v_exp_f32 v86, v86
    v_exp_f32 v87, v87
    v_exp_f32 v88, v88
    v_smfmac_f32_32x32x32_bf16 v[192:207], a[36:39], v[72:79], v23
    v_exp_f32 v89, v89
    v_exp_f32 v90, v90
    v_exp_f32 v91, v91
    v_smfmac_f32_16x16x64_bf16 a[8:11], a[48:51], v[64:71], v23
    v_exp_f32 v92, v92
    v_exp_f32 v93, v93
    v_smfmac_f32_16x16x64_bf16 a[8:11], a[48:51], v[72:79], v23
    v_exp_f32 v94, v94
    v_exp_f32 v95, v95
    v_mfma_f32_32x32x16_bf16 v[48:63], a[24:27], v[232:235], v[112:127]
    s_add_u32 s71, s71, 0x8000
    v_exp_f32 v32, v32
    v_exp_f32 v33, v33
    v_exp_f32 v34, v34
    v_smfmac_f32_32x32x32_bf16 v[208:223], a[32:35], v[80:87], v23
    s_and_b32 s71, s71, 0x1ffff
    s_add_u32 s39, s39, 1
    v_exp_f32 v35, v35
    v_exp_f32 v36, v36
    v_exp_f32 v37, v37
    v_mfma_f32_32x32x16_bf16 v[48:63], a[28:31], v[236:239], v[48:63]
    s_bitcmp1_b32 0x54, s39
    v_exp_f32 v38, v38
    v_exp_f32 v39, v39
    v_exp_f32 v40, v40
    v_smfmac_f32_32x32x32_bf16 v[208:223], a[36:39], v[88:95], v23
    s_waitcnt lgkmcnt(0)
    s_cbranch_scc0 L_at_top
    s_cbranch_vccz L_at_top_bar
    s_branch L_at_switch
L_at_exit:
    v_exp_f32 v94, v94
    v_exp_f32 v95, v95
    v_mfma_f32_32x32x16_bf16 v[48:63], a[16:19], v[232:235], v[112:127]
    v_exp_f32 v32, v32
    v_exp_f32 v33, v33
    v_exp_f32 v34, v34
    v_smfmac_f32_32x32x32_bf16 v[208:223], a[40:43], v[80:87], v23
    s_cmp_eq_u32 s28, 0
    s_cselect_b32 s50, 1.0, -1.0
    v_exp_f32 v35, v35
    v_exp_f32 v36, v36
    v_exp_f32 v37, v37
    v_mfma_f32_32x32x16_bf16 v[48:63], a[20:23], v[236:239], v[48:63]
    s_cselect_b32 s51, 0, 1.0
    v_exp_f32 v38, v38
    v_exp_f32 v39, v39
    v_exp_f32 v40, v40
    v_smfmac_f32_32x32x32_bf16 v[208:223], a[44:47], v[88:95], v23
    s_waitcnt lgkmcnt(0)
    v_exp_f32 v41, v41
    v_exp_f32 v42, v42
    v_exp_f32 v43, v43
    v_mov_b32 v31, s51
    v_fma_f32 v26, v26, s50, v31
    v_fma_f32 v27, v27, s50, v31
    v_mov_b32 v31, 0
    v_smfmac_f32_16x16x64_bf16 a[12:15], a[48:51], v[80:87], v23
    ds_read_b128 a[64:67], v22 offset:20480
    v_exp_f32 v44, v44
    v_exp_f32 v45, v45
    v_smfmac_f32_16x16x64_bf16 a[12:15], a[48:51], v[88:95], v23
    ds_read_b128 a[68:71], v22 offset:21504
    v_exp_f32 v46, v46
    v_exp_f32 v47, v47
    v_mfma_f32_32x32x16_bf16 v[64:79], a[16:19], v[240:243], v[128:143]
    s_mov_b32 s34, s32
    s_add_u32 m0, s36, 131072
    v_exp_f32 v48, v48
    v_exp_f32 v49, v49
    v_exp_f32 v50, v50
    v_smfmac_f32_32x32x32_bf16 v[160:175], a[32:35], v[32:39], v23
    buffer_load_dwordx4 v12, s[12:15], s34 offen offset:0 lds
    v_exp_f32 v51, v51
    v_exp_f32 v52, v52
    v_exp_f32 v53, v53
    v_mfma_f32_32x32x16_bf16 v[64:79], a[20:23], v[244:247], v[64:79]
    v_exp_f32 v54, v54
    v_exp_f32 v55, v55
    v_exp_f32 v56, v56
    v_smfmac_f32_32x32x32_bf16 v[160:175], a[36:39], v[40:47], v23
    s_waitcnt lgkmcnt(0)
    buffer_load_dwordx4 v13, s[12:15], s34 offen offset:1024 lds
    v_exp_f32 v57, v57
    v_exp_f32 v58, v58
    v_exp_f32 v59, v59
    v_smfmac_f32_16x16x64_bf16 a[0:3], a[48:51], v[32:39], v23
    ds_read_b128 a[80:83], v22 offset:24576
    v_exp_f32 v60, v60
    v_exp_f32 v61, v61
    v_smfmac_f32_16x16x64_bf16 a[0:3], a[48:51], v[40:47], v23
    ds_read_b128 a[84:87], v22 offset:25600
    v_exp_f32 v62, v62
    v_exp_f32 v63, v63
    v_mfma_f32_32x32x16_bf16 v[80:95], a[16:19], v[248:251], v[144:159]
    v_exp_f32 v64, v64
    v_exp_f32 v65, v65
    v_exp_f32 v66, v66
    v_smfmac_f32_32x32x32_bf16 v[176:191], a[32:35], v[48:55], v23
    buffer_load_dwordx4 v14, s[12:15], s34 offen offset:2048 lds
    v_exp_f32 v67, v67
    v_exp_f32 v68, v68
    v_exp_f32 v69, v69
    v_mfma_f32_32x32x16_bf16 v[80:95], a[20:23], v[252:255], v[80:95]
    v_exp_f32 v70, v70
    v_exp_f32 v71, v71
    v_exp_f32 v72, v72
    v_smfmac_f32_32x32x32_bf16 v[176:191], a[36:39], v[56:63], v23
    s_waitcnt lgkmcnt(0)
    buffer_load_dwordx4 v15, s[12:15], s34 offen offset:3072 lds
    v_exp_f32 v73, v73
    v_exp_f32 v74, v74
    v_exp_f32 v75, v75
    v_smfmac_f32_16x16x64_bf16 a[4:7], a[48:51], v[48:55], v23
    ds_read_b128 a[72:75], v22 offset:22528
    v_exp_f32 v76, v76
    v_exp_f32 v77, v77
    v_smfmac_f32_16x16x64_bf16 a[4:7], a[48:51], v[56:63], v23
    ds_read_b128 a[76:79], v22 offset:23552
    v_exp_f32 v78, v78
    v_exp_f32 v79, v79
    v_mfma_f32_32x32x16_bf16 v[32:47], a[64:67], v[224:227], v[96:111]
    s_add_u32 s34, s34, 0x40000
    s_and_b32 s34, s34, 0x1fffff
    s_add_u32 m0, s36, 147456
    v_exp_f32 v80, v80
    v_exp_f32 v81, v81
    v_exp_f32 v82, v82
    v_smfmac_f32_32x32x32_bf16 v[192:207], a[32:35], v[64:71], v23
    buffer_load_dwordx4 v12, s[12:15], s34 offen offset:0 lds
    v_exp_f32 v83, v83
    v_exp_f32 v84, v84
    v_exp_f32 v85, v85
    v_mfma_f32_32x32x16_bf16 v[32:47], a[68:71], v[228:231], v[32:47]
    v_exp_f32 v86, v86
    v_exp_f32 v87, v87
    v_exp_f32 v88, v88
    v_smfmac_f32_32x32x32_bf16 v[192:207], a[36:39], v[72:79], v23
    s_waitcnt lgkmcnt(0)
    buffer_load_dwordx4 v13, s[12:15], s34 offen offset:1024 lds
    v_exp_f32 v89, v89
    v_exp_f32 v90, v90
    v_exp_f32 v91, v91
    v_smfmac_f32_16x16x64_bf16 a[8:11], a[48:51], v[64:71], v23
    ds_read_b128 a[96:99], v22 offset:28672
    v_exp_f32 v92, v92
    v_exp_f32 v93, v93
    v_smfmac_f32_16x16x64_bf16 a[8:11], a[48:51], v[72:79], v23
    ds_read_b128 a[100:103], v22 offset:29696
    v_exp_f32 v94, v94
    v_exp_f32 v95, v95
    v_mfma_f32_32x32x16_bf16 v[48:63], a[80:83], v[224:227], v[96:111]
    v_exp_f32 v32, v32
    v_exp_f32 v33, v33
    v_exp_f32 v34, v34
    v_smfmac_f32_32x32x32_bf16 v[208:223], a[32:35], v[80:87], v23
    buffer_load_dwordx4 v14, s[12:15], s34 offen offset:2048 lds
    v_exp_f32 v35, v35
    v_exp_f32 v36, v36
    v_exp_f32 v37, v37
    v_mfma_f32_32x32x16_bf16 v[48:63], a[84:87], v[228:231], v[48:63]
    v_exp_f32 v38, v38
    v_exp_f32 v39, v39
    v_exp_f32 v40, v40
    v_smfmac_f32_32x32x32_bf16 v[208:223], a[36:39], v[88:95], v23
    s_waitcnt lgkmcnt(0)
    buffer_load_dwordx4 v15, s[12:15], s34 offen offset:3072 lds
    v_exp_f32 v41, v41
    v_exp_f32 v42, v42
    v_exp_f32 v43, v43
    v_smfmac_f32_16x16x64_bf16 a[12:15], a[48:51], v[80:87], v23
    ds_read_b128 a[88:91], v22 offset:26624
    v_exp_f32 v44, v44
    v_exp_f32 v45, v45
    v_smfmac_f32_16x16x64_bf16 a[12:15], a[48:51], v[88:95], v23
    ds_read_b128 a[92:95], v22 offset:27648
    v_exp_f32 v46, v46
    v_exp_f32 v47, v47
    v_mfma_f32_32x32x16_bf16 v[64:79], a[96:99], v[224:227], v[96:111]
    v_exp_f32 v48, v48
    v_exp_f32 v49, v49
    v_exp_f32 v50, v50
    v_smfmac_f32_32x32x32_bf16 v[160:175], a[72:75], v[32:39], v23
    v_exp_f32 v51, v51
    v_exp_f32 v52, v52
    v_exp_f32 v53, v53
    v_mfma_f32_32x32x16_bf16 v[64:79], a[100:103], v[228:231], v[64:79]
    v_exp_f32 v54, v54
    v_exp_f32 v55, v55
    v_exp_f32 v56, v56
    v_smfmac_f32_32x32x32_bf16 v[160:175], a[76:79], v[40:47], v23
    s_waitcnt lgkmcnt(0)
    v_exp_f32 v57, v57
    v_exp_f32 v58, v58
    v_exp_f32 v59, v59
    v_smfmac_f32_16x16x64_bf16 a[0:3], a[48:51], v[32:39], v23
    ds_read_b128 a[104:107], v22 offset:30720
    v_exp_f32 v60, v60
    v_exp_f32 v61, v61
    v_smfmac_f32_16x16x64_bf16 a[0:3], a[48:51], v[40:47], v23
    ds_read_b128 a[108:111], v22 offset:31744
    v_exp_f32 v62, v62
    v_exp_f32 v63, v63
    v_mfma_f32_32x32x16_bf16 v[80:95], a[64:67], v[232:235], v[112:127]
    v_exp_f32 v64, v64
    v_exp_f32 v65, v65
    v_exp_f32 v66, v66
    v_smfmac_f32_32x32x32_bf16 v[160:175], a[88:91], v[48:55], v23
    v_exp_f32 v67, v67
    v_exp_f32 v68, v68
    v_exp_f32 v69, v69
    v_mfma_f32_32x32x16_bf16 v[80:95], a[68:71], v[236:239], v[80:95]
    v_exp_f32 v70, v70
    v_exp_f32 v71, v71
    v_exp_f32 v72, v72
    v_smfmac_f32_32x32x32_bf16 v[160:175], a[92:95], v[56:63], v23
    s_waitcnt vmcnt(9) lgkmcnt(0)
    s_barrier
    s_add_u32 s34, s34, 0x40000
    s_and_b32 s34, s34, 0x1fffff
    s_add_u32 m0, s36, 65536
    v_exp_f32 v73, v73
    v_exp_f32 v74, v74
    v_exp_f32 v75, v75
    v_smfmac_f32_16x16x64_bf16 a[0:3], a[48:51], v[48:55], v23
    buffer_load_dwordx4 v12, s[12:15], s34 offen offset:0 lds
    v_exp_f32 v76, v76
    v_exp_f32 v77, v77
    v_smfmac_f32_16x16x64_bf16 a[0:3], a[48:51], v[56:63], v23
    buffer_load_dwordx4 v13, s[12:15], s34 offen offset:1024 lds
    v_exp_f32 v78, v78
    v_exp_f32 v79, v79
    v_mfma_f32_32x32x16_bf16 v[32:47], a[80:83], v[232:235], v[112:127]
    v_exp_f32 v80, v80
    v_exp_f32 v81, v81
    v_exp_f32 v82, v82
    v_smfmac_f32_32x32x32_bf16 v[160:175], a[104:107], v[64:71], v23
    v_exp_f32 v83, v83
    v_exp_f32 v84, v84
    v_exp_f32 v85, v85
    v_mfma_f32_32x32x16_bf16 v[32:47], a[84:87], v[236:239], v[32:47]
    v_exp_f32 v86, v86
    v_exp_f32 v87, v87
    v_exp_f32 v88, v88
    v_smfmac_f32_32x32x32_bf16 v[160:175], a[108:111], v[72:79], v23
    v_exp_f32 v89, v89
    v_exp_f32 v90, v90
    v_exp_f32 v91, v91
    v_smfmac_f32_16x16x64_bf16 a[0:3], a[48:51], v[64:71], v23
    buffer_load_dwordx4 v14, s[12:15], s34 offen offset:2048 lds
    v_exp_f32 v92, v92
    v_exp_f32 v93, v93
    v_smfmac_f32_16x16x64_bf16 a[0:3], a[48:51], v[72:79], v23
    buffer_load_dwordx4 v15, s[12:15], s34 offen offset:3072 lds
    v_exp_f32 v94, v94
    v_exp_f32 v95, v95
    v_mfma_f32_32x32x16_bf16 v[48:63], a[96:99], v[232:235], v[112:127]
    v_exp_f32 v32, v32
    v_exp_f32 v33, v33
    v_exp_f32 v34, v34
    v_smfmac_f32_32x32x32_bf16 v[176:191], a[72:75], v[80:87], v23
    v_exp_f32 v35, v35
    v_exp_f32 v36, v36
    v_exp_f32 v37, v37
    v_accvgpr_read_b32 v24, a0
    v_accvgpr_read_b32 v25, a0
    v_mfma_f32_32x32x16_bf16 v[48:63], a[100:103], v[236:239], v[48:63]
    v_exp_f32 v38, v38
    v_exp_f32 v39, v39
    v_exp_f32 v40, v40
    v_permlane32_swap_b32 v24, v25
    v_smfmac_f32_32x32x32_bf16 v[176:191], a[76:79], v[88:95], v23
    s_add_u32 s34, s34, 0x40000
    s_and_b32 s34, s34, 0x1fffff
    s_add_u32 m0, s36, 81920
    v_exp_f32 v41, v41
    v_exp_f32 v42, v42
    v_exp_f32 v43, v43
    v_add_f32 v31, v31, v24
    v_rcp_f32 v24, v24
    s_nop 0
    v_mul_f32 v24, v24, v26
    v_pk_mul_f32 v[160:161], v[160:161], v[24:25] op_sel_hi:[1,0]
    v_pk_mul_f32 v[162:163], v[162:163], v[24:25] op_sel_hi:[1,0]
    v_pk_mul_f32 v[164:165], v[164:165], v[24:25] op_sel_hi:[1,0]
    v_pk_mul_f32 v[166:167], v[166:167], v[24:25] op_sel_hi:[1,0]
    v_pk_mul_f32 v[168:169], v[168:169], v[24:25] op_sel_hi:[1,0]
    v_pk_mul_f32 v[170:171], v[170:171], v[24:25] op_sel_hi:[1,0]
    v_pk_mul_f32 v[172:173], v[172:173], v[24:25] op_sel_hi:[1,0]
    v_pk_mul_f32 v[174:175], v[174:175], v[24:25] op_sel_hi:[1,0]
    v_smfmac_f32_16x16x64_bf16 a[4:7], a[48:51], v[80:87], v23
    buffer_load_dwordx4 v12, s[12:15], s34 offen offset:0 lds
    v_exp_f32 v44, v44
    v_exp_f32 v45, v45
    v_cvt_pk_bf16_f32 v96, v160, v161
    v_cvt_pk_bf16_f32 v97, v162, v163
    v_cvt_pk_bf16_f32 v98, v164, v165
    v_cvt_pk_bf16_f32 v99, v166, v167
    v_cvt_pk_bf16_f32 v100, v168, v169
    v_cvt_pk_bf16_f32 v101, v170, v171
    v_cvt_pk_bf16_f32 v102, v172, v173
    v_cvt_pk_bf16_f32 v103, v174, v175
    v_smfmac_f32_16x16x64_bf16 a[4:7], a[48:51], v[88:95], v23
    buffer_store_dwordx4 v[96:99], v28, s[16:19], s40 offen offset:0 sc1
    buffer_store_dwordx4 v[100:103], v28, s[16:19], s40 offen offset:1024 sc1
    v_exp_f32 v46, v46
    v_exp_f32 v47, v47
    v_mfma_f32_32x32x16_bf16 v[64:79], a[64:67], v[240:243], v[128:143]
    v_exp_f32 v48, v48
    v_exp_f32 v49, v49
    v_exp_f32 v50, v50
    v_smfmac_f32_32x32x32_bf16 v[176:191], a[88:91], v[32:39], v23
    v_exp_f32 v51, v51
    v_exp_f32 v52, v52
    v_exp_f32 v53, v53
    v_mfma_f32_32x32x16_bf16 v[64:79], a[68:71], v[244:247], v[64:79]
    v_exp_f32 v54, v54
    v_exp_f32 v55, v55
    v_exp_f32 v56, v56
    v_smfmac_f32_32x32x32_bf16 v[176:191], a[92:95], v[40:47], v23
    v_exp_f32 v57, v57
    v_exp_f32 v58, v58
    v_exp_f32 v59, v59
    v_smfmac_f32_16x16x64_bf16 a[4:7], a[48:51], v[32:39], v23
    buffer_load_dwordx4 v13, s[12:15], s34 offen offset:1024 lds
    v_exp_f32 v60, v60
    v_exp_f32 v61, v61
    v_smfmac_f32_16x16x64_bf16 a[4:7], a[48:51], v[40:47], v23
    buffer_load_dwordx4 v14, s[12:15], s34 offen offset:2048 lds
    v_exp_f32 v62, v62
    v_exp_f32 v63, v63
    v_mfma_f32_32x32x16_bf16 v[80:95], a[80:83], v[240:243], v[128:143]
    v_exp_f32 v64, v64
    v_exp_f32 v65, v65
    v_exp_f32 v66, v66
    v_smfmac_f32_32x32x32_bf16 v[176:191], a[104:107], v[48:55], v23
    v_exp_f32 v67, v67
    v_exp_f32 v68, v68
    v_exp_f32 v69, v69
    v_mfma_f32_32x32x16_bf16 v[80:95], a[84:87], v[244:247], v[80:95]
    v_exp_f32 v70, v70
    v_exp_f32 v71, v71
    v_exp_f32 v72, v72
    v_smfmac_f32_32x32x32_bf16 v[176:191], a[108:111], v[56:63], v23
    v_exp_f32 v73, v73
    v_exp_f32 v74, v74
    v_exp_f32 v75, v75
    v_smfmac_f32_16x16x64_bf16 a[4:7], a[48:51], v[48:55], v23
    buffer_load_dwordx4 v15, s[12:15], s34 offen offset:3072 lds
    s_add_u32 s34, s34, 0x40000
    s_and_b32 s34, s34, 0x1fffff
    s_mov_b32 s12, s74
    s_mov_b32 s13, s75
    s_add_u32 m0, s36, 98304
    v_exp_f32 v76, v76
    v_exp_f32 v77, v77
    v_smfmac_f32_16x16x64_bf16 a[4:7], a[48:51], v[56:63], v23
    buffer_load_dwordx4 v12, s[12:15], s34 offen offset:0 lds
    v_exp_f32 v78, v78
    v_exp_f32 v79, v79
    v_mfma_f32_32x32x16_bf16 v[32:47], a[96:99], v[240:243], v[128:143]
    v_exp_f32 v80, v80
    v_exp_f32 v81, v81
    v_exp_f32 v82, v82
    v_smfmac_f32_32x32x32_bf16 v[192:207], a[72:75], v[64:71], v23
    v_exp_f32 v83, v83
    v_exp_f32 v84, v84
    v_exp_f32 v85, v85
    v_accvgpr_read_b32 v24, a4
    v_accvgpr_read_b32 v25, a4
    v_mfma_f32_32x32x16_bf16 v[32:47], a[100:103], v[244:247], v[32:47]
    v_exp_f32 v86, v86
    v_exp_f32 v87, v87
    v_exp_f32 v88, v88
    v_permlane32_swap_b32 v24, v25
    v_smfmac_f32_32x32x32_bf16 v[192:207], a[76:79], v[72:79], v23
    v_exp_f32 v89, v89
    v_exp_f32 v90, v90
    v_exp_f32 v91, v91
    v_add_f32 v31, v31, v24
    v_rcp_f32 v24, v24
    s_nop 0
    v_mul_f32 v24, v24, v27
    v_pk_mul_f32 v[176:177], v[176:177], v[24:25] op_sel_hi:[1,0]
    v_pk_mul_f32 v[178:179], v[178:179], v[24:25] op_sel_hi:[1,0]
    v_pk_mul_f32 v[180:181], v[180:181], v[24:25] op_sel_hi:[1,0]
    v_pk_mul_f32 v[182:183], v[182:183], v[24:25] op_sel_hi:[1,0]
    v_pk_mul_f32 v[184:185], v[184:185], v[24:25] op_sel_hi:[1,0]
    v_pk_mul_f32 v[186:187], v[186:187], v[24:25] op_sel_hi:[1,0]
    v_pk_mul_f32 v[188:189], v[188:189], v[24:25] op_sel_hi:[1,0]
    v_pk_mul_f32 v[190:191], v[190:191], v[24:25] op_sel_hi:[1,0]
    v_smfmac_f32_16x16x64_bf16 a[8:11], a[48:51], v[64:71], v23
    buffer_load_dwordx4 v13, s[12:15], s34 offen offset:1024 lds
    v_exp_f32 v92, v92
    v_exp_f32 v93, v93
    v_cvt_pk_bf16_f32 v112, v176, v177
    v_cvt_pk_bf16_f32 v113, v178, v179
    v_cvt_pk_bf16_f32 v114, v180, v181
    v_cvt_pk_bf16_f32 v115, v182, v183
    v_cvt_pk_bf16_f32 v116, v184, v185
    v_cvt_pk_bf16_f32 v117, v186, v187
    v_cvt_pk_bf16_f32 v118, v188, v189
    v_cvt_pk_bf16_f32 v119, v190, v191
    v_smfmac_f32_16x16x64_bf16 a[8:11], a[48:51], v[72:79], v23
    buffer_store_dwordx4 v[112:115], v28, s[16:19], s41 offen offset:0 sc1
    buffer_store_dwordx4 v[116:119], v28, s[16:19], s41 offen offset:1024 sc1
    v_exp_f32 v94, v94
    v_exp_f32 v95, v95
    v_mfma_f32_32x32x16_bf16 v[48:63], a[64:67], v[248:251], v[144:159]
    v_exp_f32 v32, v32
    v_exp_f32 v33, v33
    v_exp_f32 v34, v34
    v_smfmac_f32_32x32x32_bf16 v[192:207], a[88:91], v[80:87], v23
    v_exp_f32 v35, v35
    v_exp_f32 v36, v36
    v_exp_f32 v37, v37
    v_mfma_f32_32x32x16_bf16 v[48:63], a[68:71], v[252:255], v[48:63]
    v_exp_f32 v38, v38
    v_exp_f32 v39, v39
    v_exp_f32 v40, v40
    v_smfmac_f32_32x32x32_bf16 v[192:207], a[92:95], v[88:95], v23
    v_exp_f32 v41, v41
    v_exp_f32 v42, v42
    v_exp_f32 v43, v43
    v_smfmac_f32_16x16x64_bf16 a[8:11], a[48:51], v[80:87], v23
    buffer_load_dwordx4 v14, s[12:15], s34 offen offset:2048 lds
    v_exp_f32 v44, v44
    v_exp_f32 v45, v45
    v_smfmac_f32_16x16x64_bf16 a[8:11], a[48:51], v[88:95], v23
    buffer_load_dwordx4 v15, s[12:15], s34 offen offset:3072 lds
    v_exp_f32 v46, v46
    v_exp_f32 v47, v47
    v_mfma_f32_32x32x16_bf16 v[64:79], a[80:83], v[248:251], v[144:159]
    v_exp_f32 v48, v48
    v_exp_f32 v49, v49
    v_exp_f32 v50, v50
    v_smfmac_f32_32x32x32_bf16 v[192:207], a[104:107], v[32:39], v23
    buffer_load_dword v30, v18, s[16:19], s6 offen sc1
    v_exp_f32 v51, v51
    v_exp_f32 v52, v52
    v_exp_f32 v53, v53
    v_mfma_f32_32x32x16_bf16 v[64:79], a[84:87], v[252:255], v[64:79]
    v_exp_f32 v54, v54
    v_exp_f32 v55, v55
    v_exp_f32 v56, v56
    v_smfmac_f32_32x32x32_bf16 v[192:207], a[108:111], v[40:47], v23
    s_add_u32 s34, s34, 0x40000
    s_and_b32 s34, s34, 0x1fffff
    s_add_u32 m0, s36, 114688
    v_exp_f32 v57, v57
    v_exp_f32 v58, v58
    v_exp_f32 v59, v59
    v_smfmac_f32_16x16x64_bf16 a[8:11], a[48:51], v[32:39], v23
    buffer_load_dwordx4 v12, s[12:15], s34 offen offset:0 lds
    v_exp_f32 v60, v60
    v_exp_f32 v61, v61
    v_smfmac_f32_16x16x64_bf16 a[8:11], a[48:51], v[40:47], v23
    buffer_load_dwordx4 v13, s[12:15], s34 offen offset:1024 lds
    v_exp_f32 v62, v62
    v_exp_f32 v63, v63
    v_mfma_f32_32x32x16_bf16 v[80:95], a[96:99], v[248:251], v[144:159]
    v_exp_f32 v64, v64
    v_exp_f32 v65, v65
    v_exp_f32 v66, v66
    v_smfmac_f32_32x32x32_bf16 v[208:223], a[72:75], v[48:55], v23
    v_exp_f32 v67, v67
    v_exp_f32 v68, v68
    v_exp_f32 v69, v69
    v_accvgpr_read_b32 v24, a8
    v_accvgpr_read_b32 v25, a8
    v_mfma_f32_32x32x16_bf16 v[80:95], a[100:103], v[252:255], v[80:95]
    v_exp_f32 v70, v70
    v_exp_f32 v71, v71
    v_exp_f32 v72, v72
    v_permlane32_swap_b32 v24, v25
    v_smfmac_f32_32x32x32_bf16 v[208:223], a[76:79], v[56:63], v23
    v_exp_f32 v73, v73
    v_exp_f32 v74, v74
    v_exp_f32 v75, v75
    v_add_f32 v31, v31, v24
    v_rcp_f32 v24, v24
    s_nop 0
    v_mul_f32 v24, v24, v26
    v_pk_mul_f32 v[192:193], v[192:193], v[24:25] op_sel_hi:[1,0]
    v_pk_mul_f32 v[194:195], v[194:195], v[24:25] op_sel_hi:[1,0]
    v_pk_mul_f32 v[196:197], v[196:197], v[24:25] op_sel_hi:[1,0]
    v_pk_mul_f32 v[198:199], v[198:199], v[24:25] op_sel_hi:[1,0]
    v_pk_mul_f32 v[200:201], v[200:201], v[24:25] op_sel_hi:[1,0]
    v_pk_mul_f32 v[202:203], v[202:203], v[24:25] op_sel_hi:[1,0]
    v_pk_mul_f32 v[204:205], v[204:205], v[24:25] op_sel_hi:[1,0]
    v_pk_mul_f32 v[206:207], v[206:207], v[24:25] op_sel_hi:[1,0]
    v_smfmac_f32_16x16x64_bf16 a[12:15], a[48:51], v[48:55], v23
    buffer_load_dwordx4 v14, s[12:15], s34 offen offset:2048 lds
    v_exp_f32 v76, v76
    v_exp_f32 v77, v77
    v_cvt_pk_bf16_f32 v128, v192, v193
    v_cvt_pk_bf16_f32 v129, v194, v195
    v_cvt_pk_bf16_f32 v130, v196, v197
    v_cvt_pk_bf16_f32 v131, v198, v199
    v_cvt_pk_bf16_f32 v132, v200, v201
    v_cvt_pk_bf16_f32 v133, v202, v203
    v_cvt_pk_bf16_f32 v134, v204, v205
    v_cvt_pk_bf16_f32 v135, v206, v207
    v_smfmac_f32_16x16x64_bf16 a[12:15], a[48:51], v[56:63], v23
    buffer_store_dwordx4 v[128:131], v28, s[16:19], s40 offen offset:2048 sc1
    buffer_store_dwordx4 v[132:135], v28, s[16:19], s40 offen offset:3072 sc1
    v_exp_f32 v78, v78
    v_exp_f32 v79, v79
    v_exp_f32 v80, v80
    v_exp_f32 v81, v81
    v_exp_f32 v82, v82
    v_smfmac_f32_32x32x32_bf16 v[208:223], a[88:91], v[64:71], v23
    v_exp_f32 v83, v83
    v_exp_f32 v84, v84
    v_exp_f32 v85, v85
    v_exp_f32 v86, v86
    v_exp_f32 v87, v87
    v_exp_f32 v88, v88
    v_smfmac_f32_32x32x32_bf16 v[208:223], a[92:95], v[72:79], v23
    v_exp_f32 v89, v89
    v_exp_f32 v90, v90
    v_exp_f32 v91, v91
    v_smfmac_f32_16x16x64_bf16 a[12:15], a[48:51], v[64:71], v23
    buffer_load_dwordx4 v15, s[12:15], s34 offen offset:3072 lds
    v_exp_f32 v92, v92
    v_exp_f32 v93, v93
    v_smfmac_f32_16x16x64_bf16 a[12:15], a[48:51], v[72:79], v23
    v_exp_f32 v94, v94
    v_exp_f32 v95, v95
    v_smfmac_f32_16x16x64_bf16 a[12:15], a[48:51], v[80:87], v23
    s_add_u32 s34, s34, 0x40000
    s_and_b32 s34, s34, 0x1fffff
    v_smfmac_f32_16x16x64_bf16 a[12:15], a[48:51], v[88:95], v23
    v_smfmac_f32_32x32x32_bf16 v[208:223], a[104:107], v[80:87], v23
    v_smfmac_f32_32x32x32_bf16 v[208:223], a[108:111], v[88:95], v23
    s_nop 5
    v_accvgpr_read_b32 v24, a12
    v_accvgpr_read_b32 v25, a12
    s_nop 1
    v_permlane32_swap_b32 v24, v25
    s_nop 1
    v_add_f32 v31, v31, v24
    v_rcp_f32 v24, v24
    v_cmp_ngt_f32 vcc, 0x4e800000, v31
    v_mul_f32 v24, v24, v27
    v_pk_mul_f32 v[208:209], v[208:209], v[24:25] op_sel_hi:[1,0]
    v_pk_mul_f32 v[210:211], v[210:211], v[24:25] op_sel_hi:[1,0]
    v_pk_mul_f32 v[212:213], v[212:213], v[24:25] op_sel_hi:[1,0]
    v_pk_mul_f32 v[214:215], v[214:215], v[24:25] op_sel_hi:[1,0]
    v_pk_mul_f32 v[216:217], v[216:217], v[24:25] op_sel_hi:[1,0]
    v_pk_mul_f32 v[218:219], v[218:219], v[24:25] op_sel_hi:[1,0]
    v_pk_mul_f32 v[220:221], v[220:221], v[24:25] op_sel_hi:[1,0]
    v_pk_mul_f32 v[222:223], v[222:223], v[24:25] op_sel_hi:[1,0]
    v_cvt_pk_bf16_f32 v144, v208, v209
    v_cvt_pk_bf16_f32 v145, v210, v211
    v_cvt_pk_bf16_f32 v146, v212, v213
    v_cvt_pk_bf16_f32 v147, v214, v215
    v_cvt_pk_bf16_f32 v148, v216, v217
    v_cvt_pk_bf16_f32 v149, v218, v219
    v_cvt_pk_bf16_f32 v150, v220, v221
    v_cvt_pk_bf16_f32 v151, v222, v223
    buffer_store_dwordx4 v[144:147], v28, s[16:19], s41 offen offset:2048 sc1
    buffer_store_dwordx4 v[148:151], v28, s[16:19], s41 offen offset:3072 sc1
    s_cmp_lg_u64 vcc, 0
    s_cbranch_scc1 L_at_slow
L_at_done:
    v_mov_b32 v8, v16
    v_mov_b32 v9, v17
    s_cmp_eq_u32 s20, 0
    s_cselect_b32 s53, 0, -1
    s_mov_b32 s35, s36
    ds_read_b64_tr_b16 a[0:1], v8 offset:16384
    ds_read_b64_tr_b16 a[2:3], v8 offset:17408
    ds_read_b64_tr_b16 a[4:5], v9 offset:16384
    ds_read_b64_tr_b16 a[6:7], v9 offset:17408
    ds_read_b64_tr_b16 a[8:9], v8 offset:18432
    ds_read_b64_tr_b16 a[10:11], v8 offset:19456
    ds_read_b64_tr_b16 a[12:13], v9 offset:18432
    ds_read_b64_tr_b16 a[14:15], v9 offset:19456
    ds_read_b64_tr_b16 a[16:17], v8 offset:20480
    ds_read_b64_tr_b16 a[18:19], v8 offset:21504
    ds_read_b64_tr_b16 a[20:21], v9 offset:20480
    ds_read_b64_tr_b16 a[22:23], v9 offset:21504
    ds_read_b64_tr_b16 a[24:25], v8 offset:22528
    ds_read_b64_tr_b16 a[26:27], v8 offset:23552
    ds_read_b64_tr_b16 a[28:29], v9 offset:22528
    ds_read_b64_tr_b16 a[30:31], v9 offset:23552
    ds_read_b64_tr_b16 a[32:33], v8 offset:24576
    ds_read_b64_tr_b16 a[34:35], v8 offset:25600
    ds_read_b64_tr_b16 a[36:37], v9 offset:24576
    ds_read_b64_tr_b16 a[38:39], v9 offset:25600
    ds_read_b64_tr_b16 a[40:41], v8 offset:26624
    ds_read_b64_tr_b16 a[42:43], v8 offset:27648
    ds_read_b64_tr_b16 a[44:45], v9 offset:26624
    ds_read_b64_tr_b16 a[46:47], v9 offset:27648
    ds_read_b64_tr_b16 a[48:49], v8 offset:28672
    ds_read_b64_tr_b16 a[50:51], v8 offset:29696
    ds_read_b64_tr_b16 a[52:53], v9 offset:28672
    ds_read_b64_tr_b16 a[54:55], v9 offset:29696
    ds_read_b64_tr_b16 a[56:57], v8 offset:30720
    ds_read_b64_tr_b16 a[58:59], v8 offset:31744
    ds_read_b64_tr_b16 a[60:61], v9 offset:30720
    ds_read_b64_tr_b16 a[62:63], v9 offset:31744
    ds_read_b64_tr_b16 v[160:161], v8 offset:8192
    ds_read_b64_tr_b16 v[162:163], v8 offset:9216
    ds_read_b64_tr_b16 v[164:165], v9 offset:8192
    ds_read_b64_tr_b16 v[166:167], v9 offset:9216
    ds_read_b64_tr_b16 v[168:169], v8 offset:10240
    ds_read_b64_tr_b16 v[170:171], v8 offset:11264
    ds_read_b64_tr_b16 v[172:173], v9 offset:10240
    ds_read_b64_tr_b16 v[174:175], v9 offset:11264
    ds_read_b64_tr_b16 v[176:177], v8 offset:12288
    ds_read_b64_tr_b16 v[178:179], v8 offset:13312
    ds_read_b64_tr_b16 v[180:181], v9 offset:12288
    ds_read_b64_tr_b16 v[182:183], v9 offset:13312
    ds_read_b64_tr_b16 v[184:185], v8 offset:14336
    ds_read_b64_tr_b16 v[186:187], v8 offset:15360
    ds_read_b64_tr_b16 v[188:189], v9 offset:14336
    ds_read_b64_tr_b16 v[190:191], v9 offset:15360
    ds_read_b64_tr_b16 v[128:129], v8 offset:0
    ds_read_b64_tr_b16 v[130:131], v8 offset:1024
    ds_read_b64_tr_b16 v[132:133], v9 offset:0
    ds_read_b64_tr_b16 v[134:135], v9 offset:1024
    ds_read_b64_tr_b16 v[136:137], v8 offset:2048
    ds_read_b64_tr_b16 v[138:139], v8 offset:3072
    ds_read_b64_tr_b16 v[140:141], v9 offset:2048
    ds_read_b64_tr_b16 v[142:143], v9 offset:3072
    ds_read_b64_tr_b16 v[144:145], v8 offset:4096
    ds_read_b64_tr_b16 v[146:147], v8 offset:5120
    ds_read_b64_tr_b16 v[148:149], v9 offset:4096
    ds_read_b64_tr_b16 v[150:151], v9 offset:5120
    ds_read_b64_tr_b16 v[152:153], v8 offset:6144
    ds_read_b64_tr_b16 v[154:155], v8 offset:7168
    ds_read_b64_tr_b16 v[156:157], v9 offset:6144
    ds_read_b64_tr_b16 v[158:159], v9 offset:7168
    s_waitcnt vmcnt(0) lgkmcnt(0)
    s_barrier
    s_cmp_lg_u32 s20, 0
    s_cbranch_scc1 L_o_nosig
    v_mov_b32 v19, 1
    v_mov_b32 v27, 0
    s_mov_b64 exec, 1
    buffer_atomic_swap v19, v27, s[16:19], s69 offen sc1
    s_mov_b64 exec, -1
L_o_nosig:
    buffer_load_dwordx4 v[192:195], v28, s[8:11], s3 offen offset:0 sc1
    buffer_load_dwordx4 v[196:199], v28, s[8:11], s3 offen offset:1024 sc1
    buffer_load_dwordx4 v[200:203], v28, s[8:11], s3 offen offset:2048 sc1
    buffer_load_dwordx4 v[204:207], v28, s[8:11], s3 offen offset:3072 sc1
    s_add_u32 s3, s3, 0x1000
    s_and_b32 s3, s3, 0xffff
    buffer_load_dwordx4 v[208:211], v28, s[8:11], s3 offen offset:0 sc1
    buffer_load_dwordx4 v[212:215], v28, s[8:11], s3 offen offset:1024 sc1
    buffer_load_dwordx4 v[216:219], v28, s[8:11], s3 offen offset:2048 sc1
    buffer_load_dwordx4 v[220:223], v28, s[8:11], s3 offen offset:3072 sc1
    s_add_u32 s3, s3, 0x1000
    s_and_b32 s3, s3, 0xffff
    ds_read_b64_tr_b16 a[64:65], v8 offset:32768
    ds_read_b64_tr_b16 a[66:67], v8 offset:33792
    ds_read_b64_tr_b16 a[68:69], v9 offset:32768
    ds_read_b64_tr_b16 a[70:71], v9 offset:33792
    ds_read_b64_tr_b16 a[72:73], v8 offset:34816
    ds_read_b64_tr_b16 a[74:75], v8 offset:35840
    ds_read_b64_tr_b16 a[76:77], v9 offset:34816
    ds_read_b64_tr_b16 a[78:79], v9 offset:35840
    s_mov_b32 m0, s35
    s_add_u32 s35, s35, 0x4000
    buffer_load_dwordx4 v12, s[12:15], s34 offen offset:0 lds
    ds_read_b64_tr_b16 a[80:81], v8 offset:36864
    ds_read_b64_tr_b16 a[82:83], v8 offset:37888
    ds_read_b64_tr_b16 a[84:85], v9 offset:36864
    ds_read_b64_tr_b16 a[86:87], v9 offset:37888
    ds_read_b64_tr_b16 a[88:89], v8 offset:38912
    ds_read_b64_tr_b16 a[90:91], v8 offset:39936
    ds_read_b64_tr_b16 a[92:93], v9 offset:38912
    ds_read_b64_tr_b16 a[94:95], v9 offset:39936
    buffer_load_dwordx4 v13, s[12:15], s34 offen offset:1024 lds
    ds_read_b64_tr_b16 a[96:97], v8 offset:40960
    ds_read_b64_tr_b16 a[98:99], v8 offset:41984
    ds_read_b64_tr_b16 a[100:101], v9 offset:40960
    ds_read_b64_tr_b16 a[102:103], v9 offset:41984
    ds_read_b64_tr_b16 a[104:105], v8 offset:43008
    ds_read_b64_tr_b16 a[106:107], v8 offset:44032
    ds_read_b64_tr_b16 a[108:109], v9 offset:43008
    ds_read_b64_tr_b16 a[110:111], v9 offset:44032
    buffer_load_dwordx4 v14, s[12:15], s34 offen offset:2048 lds
    ds_read_b64_tr_b16 a[112:113], v8 offset:45056
    ds_read_b64_tr_b16 a[114:115], v8 offset:46080
    ds_read_b64_tr_b16 a[116:117], v9 offset:45056
    ds_read_b64_tr_b16 a[118:119], v9 offset:46080
    ds_read_b64_tr_b16 a[120:121], v8 offset:47104
    ds_read_b64_tr_b16 a[122:123], v8 offset:48128
    ds_read_b64_tr_b16 a[124:125], v9 offset:47104
    ds_read_b64_tr_b16 a[126:127], v9 offset:48128
    buffer_load_dwordx4 v15, s[12:15], s34 offen offset:3072 lds
    s_add_u32 s34, s34, 0x40000
    s_and_b32 s34, s34, 0x1fffff
    ds_read_b64_tr_b16 a[128:129], v8 offset:49152
    ds_read_b64_tr_b16 a[130:131], v8 offset:50176
    ds_read_b64_tr_b16 a[132:133], v9 offset:49152
    ds_read_b64_tr_b16 a[134:135], v9 offset:50176
    ds_read_b64_tr_b16 a[136:137], v8 offset:51200
    ds_read_b64_tr_b16 a[138:139], v8 offset:52224
    ds_read_b64_tr_b16 a[140:141], v9 offset:51200
    ds_read_b64_tr_b16 a[142:143], v9 offset:52224
    s_mov_b32 m0, s35
    s_add_u32 s35, s35, 0x4000
    buffer_load_dwordx4 v12, s[12:15], s34 offen offset:0 lds
    ds_read_b64_tr_b16 a[144:145], v8 offset:53248
    ds_read_b64_tr_b16 a[146:147], v8 offset:54272
    ds_read_b64_tr_b16 a[148:149], v9 offset:53248
    ds_read_b64_tr_b16 a[150:151], v9 offset:54272
    ds_read_b64_tr_b16 a[152:153], v8 offset:55296
    ds_read_b64_tr_b16 a[154:155], v8 offset:56320
    ds_read_b64_tr_b16 a[156:157], v9 offset:55296
    ds_read_b64_tr_b16 a[158:159], v9 offset:56320
    buffer_load_dwordx4 v13, s[12:15], s34 offen offset:1024 lds
    ds_read_b64_tr_b16 a[160:161], v8 offset:57344
    ds_read_b64_tr_b16 a[162:163], v8 offset:58368
    ds_read_b64_tr_b16 a[164:165], v9 offset:57344
    ds_read_b64_tr_b16 a[166:167], v9 offset:58368
    ds_read_b64_tr_b16 a[168:169], v8 offset:59392
    ds_read_b64_tr_b16 a[170:171], v8 offset:60416
    ds_read_b64_tr_b16 a[172:173], v9 offset:59392
    ds_read_b64_tr_b16 a[174:175], v9 offset:60416
    buffer_load_dwordx4 v14, s[12:15], s34 offen offset:2048 lds
    ds_read_b64_tr_b16 a[176:177], v8 offset:61440
    ds_read_b64_tr_b16 a[178:179], v8 offset:62464
    ds_read_b64_tr_b16 a[180:181], v9 offset:61440
    ds_read_b64_tr_b16 a[182:183], v9 offset:62464
    ds_read_b64_tr_b16 a[184:185], v8 offset:63488
    ds_read_b64_tr_b16 a[186:187], v8 offset:64512
    ds_read_b64_tr_b16 a[188:189], v9 offset:63488
    ds_read_b64_tr_b16 a[190:191], v9 offset:64512
    buffer_load_dwordx4 v15, s[12:15], s34 offen offset:3072 lds
    s_add_u32 s34, s34, 0x40000
    s_and_b32 s34, s34, 0x1fffff
    v_add_u32 v8, 0x20000, v16
    v_add_u32 v9, 0x20000, v17
    s_waitcnt lgkmcnt(0)
    s_barrier
    ds_read_b64_tr_b16 a[192:193], v8 offset:0
    ds_read_b64_tr_b16 a[194:195], v8 offset:1024
    ds_read_b64_tr_b16 a[196:197], v9 offset:0
    ds_read_b64_tr_b16 a[198:199], v9 offset:1024
    ds_read_b64_tr_b16 a[200:201], v8 offset:2048
    ds_read_b64_tr_b16 a[202:203], v8 offset:3072
    ds_read_b64_tr_b16 a[204:205], v9 offset:2048
    ds_read_b64_tr_b16 a[206:207], v9 offset:3072
    s_mov_b32 m0, s35
    s_add_u32 s35, s35, 0x4000
    buffer_load_dwordx4 v12, s[12:15], s34 offen offset:0 lds
    ds_read_b64_tr_b16 a[208:209], v8 offset:4096
    ds_read_b64_tr_b16 a[210:211], v8 offset:5120
    ds_read_b64_tr_b16 a[212:213], v9 offset:4096
    ds_read_b64_tr_b16 a[214:215], v9 offset:5120
    ds_read_b64_tr_b16 a[216:217], v8 offset:6144
    ds_read_b64_tr_b16 a[218:219], v8 offset:7168
    ds_read_b64_tr_b16 a[220:221], v9 offset:6144
    ds_read_b64_tr_b16 a[222:223], v9 offset:7168
    buffer_load_dwordx4 v13, s[12:15], s34 offen offset:1024 lds
    ds_read_b64_tr_b16 a[224:225], v8 offset:8192
    ds_read_b64_tr_b16 a[226:227], v8 offset:9216
    ds_read_b64_tr_b16 a[228:229], v9 offset:8192
    ds_read_b64_tr_b16 a[230:231], v9 offset:9216
    ds_read_b64_tr_b16 a[232:233], v8 offset:10240
    ds_read_b64_tr_b16 a[234:235], v8 offset:11264
    ds_read_b64_tr_b16 a[236:237], v9 offset:10240
    ds_read_b64_tr_b16 a[238:239], v9 offset:11264
    buffer_load_dwordx4 v14, s[12:15], s34 offen offset:2048 lds
    ds_read_b64_tr_b16 a[240:241], v8 offset:12288
    ds_read_b64_tr_b16 a[242:243], v8 offset:13312
    ds_read_b64_tr_b16 a[244:245], v9 offset:12288
    ds_read_b64_tr_b16 a[246:247], v9 offset:13312
    ds_read_b64_tr_b16 a[248:249], v8 offset:14336
    ds_read_b64_tr_b16 a[250:251], v8 offset:15360
    ds_read_b64_tr_b16 a[252:253], v9 offset:14336
    ds_read_b64_tr_b16 a[254:255], v9 offset:15360
    buffer_load_dwordx4 v15, s[12:15], s34 offen offset:3072 lds
    s_add_u32 s34, s34, 0x40000
    s_and_b32 s34, s34, 0x1fffff
    ds_read_b64_tr_b16 v[64:65], v8 offset:16384
    ds_read_b64_tr_b16 v[66:67], v8 offset:17408
    ds_read_b64_tr_b16 v[68:69], v9 offset:16384
    ds_read_b64_tr_b16 v[70:71], v9 offset:17408
    ds_read_b64_tr_b16 v[72:73], v8 offset:18432
    ds_read_b64_tr_b16 v[74:75], v8 offset:19456
    ds_read_b64_tr_b16 v[76:77], v9 offset:18432
    ds_read_b64_tr_b16 v[78:79], v9 offset:19456
    s_mov_b32 m0, s35
    s_add_u32 s35, s35, 0x4000
    buffer_load_dwordx4 v12, s[12:15], s34 offen offset:0 lds
    ds_read_b64_tr_b16 v[80:81], v8 offset:20480
    ds_read_b64_tr_b16 v[82:83], v8 offset:21504
    ds_read_b64_tr_b16 v[84:85], v9 offset:20480
    ds_read_b64_tr_b16 v[86:87], v9 offset:21504
    ds_read_b64_tr_b16 v[88:89], v8 offset:22528
    ds_read_b64_tr_b16 v[90:91], v8 offset:23552
    ds_read_b64_tr_b16 v[92:93], v9 offset:22528
    ds_read_b64_tr_b16 v[94:95], v9 offset:23552
    buffer_load_dwordx4 v13, s[12:15], s34 offen offset:1024 lds
    ds_read_b64_tr_b16 v[96:97], v8 offset:24576
    ds_read_b64_tr_b16 v[98:99], v8 offset:25600
    ds_read_b64_tr_b16 v[100:101], v9 offset:24576
    ds_read_b64_tr_b16 v[102:103], v9 offset:25600
    ds_read_b64_tr_b16 v[104:105], v8 offset:26624
    ds_read_b64_tr_b16 v[106:107], v8 offset:27648
    ds_read_b64_tr_b16 v[108:109], v9 offset:26624
    ds_read_b64_tr_b16 v[110:111], v9 offset:27648
    buffer_load_dwordx4 v14, s[12:15], s34 offen offset:2048 lds
    ds_read_b64_tr_b16 v[112:113], v8 offset:28672
    ds_read_b64_tr_b16 v[114:115], v8 offset:29696
    ds_read_b64_tr_b16 v[116:117], v9 offset:28672
    ds_read_b64_tr_b16 v[118:119], v9 offset:29696
    ds_read_b64_tr_b16 v[120:121], v8 offset:30720
    ds_read_b64_tr_b16 v[122:123], v8 offset:31744
    ds_read_b64_tr_b16 v[124:125], v9 offset:30720
    ds_read_b64_tr_b16 v[126:127], v9 offset:31744
    buffer_load_dwordx4 v15, s[12:15], s34 offen offset:3072 lds
    s_add_u32 s34, s34, 0x40000
    s_and_b32 s34, s34, 0x1fffff
    s_add_u32 s35, s36, 0x20000
    s_waitcnt vmcnt(16) lgkmcnt(0)
    s_barrier
    s_cmp_lg_u32 s20, 0
    s_cbranch_scc1 L_o_nopoll
    buffer_load_dword v27, v18, s[16:19], s6 offen sc1
L_o_nopoll:
    v_mfma_f32_32x32x16_bf16 v[32:47], v[128:131], v[192:195], 0
    v_mfma_f32_32x32x16_bf16 v[48:63], v[132:135], v[192:195], 0
    s_mov_b32 m0, s35
    s_add_u32 s35, s35, 0x4000
    buffer_load_dwordx4 v12, s[12:15], s34 offen offset:0 lds
    v_mfma_f32_32x32x16_bf16 v[32:47], v[136:139], v[196:199], v[32:47]
    v_mfma_f32_32x32x16_bf16 v[48:63], v[140:143], v[196:199], v[48:63]
    buffer_load_dwordx4 v13, s[12:15], s34 offen offset:1024 lds
    v_mfma_f32_32x32x16_bf16 v[32:47], v[144:147], v[200:203], v[32:47]
    v_mfma_f32_32x32x16_bf16 v[48:63], v[148:151], v[200:203], v[48:63]
    buffer_load_dwordx4 v14, s[12:15], s34 offen offset:2048 lds
    v_mfma_f32_32x32x16_bf16 v[32:47], v[152:155], v[204:207], v[32:47]
    v_mfma_f32_32x32x16_bf16 v[48:63], v[156:159], v[204:207], v[48:63]
    buffer_load_dwordx4 v15, s[12:15], s34 offen offset:3072 lds
    s_add_u32 s34, s34, 0x40000
    s_and_b32 s34, s34, 0x1fffff
    v_mfma_f32_32x32x16_bf16 v[32:47], v[160:163], v[208:211], v[32:47]
    v_mfma_f32_32x32x16_bf16 v[48:63], v[164:167], v[208:211], v[48:63]
    s_mov_b32 m0, s35
    s_add_u32 s35, s35, 0x4000
    buffer_load_dwordx4 v12, s[12:15], s34 offen offset:0 lds
    v_mfma_f32_32x32x16_bf16 v[32:47], v[168:171], v[212:215], v[32:47]
    v_mfma_f32_32x32x16_bf16 v[48:63], v[172:175], v[212:215], v[48:63]
    buffer_load_dwordx4 v13, s[12:15], s34 offen offset:1024 lds
    v_mfma_f32_32x32x16_bf16 v[32:47], v[176:179], v[216:219], v[32:47]
    v_mfma_f32_32x32x16_bf16 v[48:63], v[180:183], v[216:219], v[48:63]
    buffer_load_dwordx4 v14, s[12:15], s34 offen offset:2048 lds
    v_mfma_f32_32x32x16_bf16 v[32:47], v[184:187], v[220:223], v[32:47]
    v_mfma_f32_32x32x16_bf16 v[48:63], v[188:191], v[220:223], v[48:63]
    buffer_load_dwordx4 v15, s[12:15], s34 offen offset:3072 lds
    s_add_u32 s34, s34, 0x40000
    s_and_b32 s34, s34, 0x1fffff
    s_mov_b32 s54, 0xff
    s_cmp_lg_u32 s20, 0
    s_cbranch_scc1 L_o_ready0
    s_waitcnt vmcnt(8)
    v_cmp_eq_u32 vcc, 1, v27
    s_nop 4
    s_mov_b32 s53, vcc_lo
    s_and_b32 s50, s53, s54
    s_cmp_lg_u32 s50, s54
    s_cbranch_scc1 L_o_poll0
L_o_ready0:
    s_barrier
    buffer_load_dwordx4 v[224:227], v28, s[8:11], s3 offen offset:0 sc1
    buffer_load_dwordx4 v[228:231], v28, s[8:11], s3 offen offset:1024 sc1
    buffer_load_dwordx4 v[232:235], v28, s[8:11], s3 offen offset:2048 sc1
    buffer_load_dwordx4 v[236:239], v28, s[8:11], s3 offen offset:3072 sc1
    s_add_u32 s3, s3, 0x1000
    s_and_b32 s3, s3, 0xffff
    buffer_load_dwordx4 v[240:243], v28, s[8:11], s3 offen offset:0 sc1
    buffer_load_dwordx4 v[244:247], v28, s[8:11], s3 offen offset:1024 sc1
    buffer_load_dwordx4 v[248:251], v28, s[8:11], s3 offen offset:2048 sc1
    buffer_load_dwordx4 v[252:255], v28, s[8:11], s3 offen offset:3072 sc1
    s_add_u32 s3, s3, 0x1000
    s_and_b32 s3, s3, 0xffff
    v_add_u32 v8, 0x10000, v16
    v_add_u32 v9, 0x10000, v17
    s_mov_b32 s37, 0x10000
    s_mov_b32 s39, 3
    s_waitcnt vmcnt(7)
    v_mfma_f32_32x32x16_bf16 v[32:47], a[0:3], v[224:227], v[32:47]
    buffer_load_dwordx4 v[192:195], v28, s[8:11], s3 offen offset:0 sc1
    v_mfma_f32_32x32x16_bf16 v[48:63], a[4:7], v[224:227], v[48:63]
    s_waitcnt vmcnt(7)
    v_mfma_f32_32x32x16_bf16 v[32:47], a[8:11], v[228:231], v[32:47]
    buffer_load_dwordx4 v[196:199], v28, s[8:11], s3 offen offset:1024 sc1
    v_mfma_f32_32x32x16_bf16 v[48:63], a[12:15], v[228:231], v[48:63]
    s_waitcnt vmcnt(7)
    v_mfma_f32_32x32x16_bf16 v[32:47], a[16:19], v[232:235], v[32:47]
    buffer_load_dwordx4 v[200:203], v28, s[8:11], s3 offen offset:2048 sc1
    v_mfma_f32_32x32x16_bf16 v[48:63], a[20:23], v[232:235], v[48:63]
    s_waitcnt vmcnt(7)
    v_mfma_f32_32x32x16_bf16 v[32:47], a[24:27], v[236:239], v[32:47]
    buffer_load_dwordx4 v[204:207], v28, s[8:11], s3 offen offset:3072 sc1
    s_add_u32 s3, s3, 0x1000
    s_and_b32 s3, s3, 0xffff
    v_mfma_f32_32x32x16_bf16 v[48:63], a[28:31], v[236:239], v[48:63]
    s_waitcnt vmcnt(7)
    v_mfma_f32_32x32x16_bf16 v[32:47], a[32:35], v[240:243], v[32:47]
    buffer_load_dwordx4 v[208:211], v28, s[8:11], s3 offen offset:0 sc1
    v_mfma_f32_32x32x16_bf16 v[48:63], a[36:39], v[240:243], v[48:63]
    s_waitcnt vmcnt(7)
    v_mfma_f32_32x32x16_bf16 v[32:47], a[40:43], v[244:247], v[32:47]
    buffer_load_dwordx4 v[212:215], v28, s[8:11], s3 offen offset:1024 sc1
    v_mfma_f32_32x32x16_bf16 v[48:63], a[44:47], v[244:247], v[48:63]
    s_waitcnt vmcnt(7)
    v_mfma_f32_32x32x16_bf16 v[32:47], a[48:51], v[248:251], v[32:47]
    buffer_load_dwordx4 v[216:219], v28, s[8:11], s3 offen offset:2048 sc1
    v_mfma_f32_32x32x16_bf16 v[48:63], a[52:55], v[248:251], v[48:63]
    s_waitcnt vmcnt(7)
    v_mfma_f32_32x32x16_bf16 v[32:47], a[56:59], v[252:255], v[32:47]
    buffer_load_dwordx4 v[220:223], v28, s[8:11], s3 offen offset:3072 sc1
    s_add_u32 s3, s3, 0x1000
    s_and_b32 s3, s3, 0xffff
    v_mfma_f32_32x32x16_bf16 v[48:63], a[60:63], v[252:255], v[48:63]
    s_waitcnt vmcnt(7)
    v_mfma_f32_32x32x16_bf16 v[32:47], a[64:67], v[192:195], v[32:47]
    buffer_load_dwordx4 v[224:227], v28, s[8:11], s3 offen offset:0 sc1
    v_mfma_f32_32x32x16_bf16 v[48:63], a[68:71], v[192:195], v[48:63]
    s_waitcnt vmcnt(7)
    v_mfma_f32_32x32x16_bf16 v[32:47], a[72:75], v[196:199], v[32:47]
    buffer_load_dwordx4 v[228:231], v28, s[8:11], s3 offen offset:1024 sc1
    v_mfma_f32_32x32x16_bf16 v[48:63], a[76:79], v[196:199], v[48:63]
    s_waitcnt vmcnt(7)
    v_mfma_f32_32x32x16_bf16 v[32:47], a[80:83], v[200:203], v[32:47]
    buffer_load_dwordx4 v[232:235], v28, s[8:11], s3 offen offset:2048 sc1
    v_mfma_f32_32x32x16_bf16 v[48:63], a[84:87], v[200:203], v[48:63]
    s_waitcnt vmcnt(7)
    v_mfma_f32_32x32x16_bf16 v[32:47], a[88:91], v[204:207], v[32:47]
    buffer_load_dwordx4 v[236:239], v28, s[8:11], s3 offen offset:3072 sc1
    s_add_u32 s3, s3, 0x1000
    s_and_b32 s3, s3, 0xffff
    v_mfma_f32_32x32x16_bf16 v[48:63], a[92:95], v[204:207], v[48:63]
    s_waitcnt vmcnt(7)
    v_mfma_f32_32x32x16_bf16 v[32:47], a[96:99], v[208:211], v[32:47]
    buffer_load_dwordx4 v[240:243], v28, s[8:11], s3 offen offset:0 sc1
    v_mfma_f32_32x32x16_bf16 v[48:63], a[100:103], v[208:211], v[48:63]
    s_waitcnt vmcnt(7)
    v_mfma_f32_32x32x16_bf16 v[32:47], a[104:107], v[212:215], v[32:47]
    buffer_load_dwordx4 v[244:247], v28, s[8:11], s3 offen offset:1024 sc1
    v_mfma_f32_32x32x16_bf16 v[48:63], a[108:111], v[212:215], v[48:63]
    s_waitcnt vmcnt(7)
    v_mfma_f32_32x32x16_bf16 v[32:47], a[112:115], v[216:219], v[32:47]
    buffer_load_dwordx4 v[248:251], v28, s[8:11], s3 offen offset:2048 sc1
    v_mfma_f32_32x32x16_bf16 v[48:63], a[116:119], v[216:219], v[48:63]
    s_waitcnt vmcnt(7)
    v_mfma_f32_32x32x16_bf16 v[32:47], a[120:123], v[220:223], v[32:47]
    buffer_load_dwordx4 v[252:255], v28, s[8:11], s3 offen offset:3072 sc1
    s_add_u32 s3, s3, 0x1000
    s_and_b32 s3, s3, 0xffff
    v_mfma_f32_32x32x16_bf16 v[48:63], a[124:127], v[220:223], v[48:63]
    s_waitcnt vmcnt(7)
    v_mfma_f32_32x32x16_bf16 v[32:47], a[128:131], v[224:227], v[32:47]
    buffer_load_dwordx4 v[192:195], v28, s[8:11], s3 offen offset:0 sc1
    v_mfma_f32_32x32x16_bf16 v[48:63], a[132:135], v[224:227], v[48:63]
    s_waitcnt vmcnt(7)
    v_mfma_f32_32x32x16_bf16 v[32:47], a[136:139], v[228:231], v[32:47]
    buffer_load_dwordx4 v[196:199], v28, s[8:11], s3 offen offset:1024 sc1
    v_mfma_f32_32x32x16_bf16 v[48:63], a[140:143], v[228:231], v[48:63]
    s_waitcnt vmcnt(7)
    v_mfma_f32_32x32x16_bf16 v[32:47], a[144:147], v[232:235], v[32:47]
    buffer_load_dwordx4 v[200:203], v28, s[8:11], s3 offen offset:2048 sc1
    v_mfma_f32_32x32x16_bf16 v[48:63], a[148:151], v[232:235], v[48:63]
    s_waitcnt vmcnt(7)
    v_mfma_f32_32x32x16_bf16 v[32:47], a[152:155], v[236:239], v[32:47]
    buffer_load_dwordx4 v[204:207], v28, s[8:11], s3 offen offset:3072 sc1
    s_add_u32 s3, s3, 0x1000
    s_and_b32 s3, s3, 0xffff
    v_mfma_f32_32x32x16_bf16 v[48:63], a[156:159], v[236:239], v[48:63]
    s_waitcnt vmcnt(7)
    v_mfma_f32_32x32x16_bf16 v[32:47], a[160:163], v[240:243], v[32:47]
    buffer_load_dwordx4 v[208:211], v28, s[8:11], s3 offen offset:0 sc1
    v_mfma_f32_32x32x16_bf16 v[48:63], a[164:167], v[240:243], v[48:63]
    s_waitcnt vmcnt(7)
    v_mfma_f32_32x32x16_bf16 v[32:47], a[168:171], v[244:247], v[32:47]
    buffer_load_dwordx4 v[212:215], v28, s[8:11], s3 offen offset:1024 sc1
    v_mfma_f32_32x32x16_bf16 v[48:63], a[172:175], v[244:247], v[48:63]
    s_waitcnt vmcnt(7)
    v_mfma_f32_32x32x16_bf16 v[32:47], a[176:179], v[248:251], v[32:47]
    buffer_load_dwordx4 v[216:219], v28, s[8:11], s3 offen offset:2048 sc1
    v_mfma_f32_32x32x16_bf16 v[48:63], a[180:183], v[248:251], v[48:63]
    s_waitcnt vmcnt(7)
    v_mfma_f32_32x32x16_bf16 v[32:47], a[184:187], v[252:255], v[32:47]
    buffer_load_dwordx4 v[220:223], v28, s[8:11], s3 offen offset:3072 sc1
    s_add_u32 s3, s3, 0x1000
    s_and_b32 s3, s3, 0xffff
    v_mfma_f32_32x32x16_bf16 v[48:63], a[188:191], v[252:255], v[48:63]
    s_waitcnt vmcnt(7)
    v_mfma_f32_32x32x16_bf16 v[32:47], a[192:195], v[192:195], v[32:47]
    buffer_load_dwordx4 v[224:227], v28, s[8:11], s3 offen offset:0 sc1
    v_mfma_f32_32x32x16_bf16 v[48:63], a[196:199], v[192:195], v[48:63]
    s_waitcnt vmcnt(7)
    v_mfma_f32_32x32x16_bf16 v[32:47], a[200:203], v[196:199], v[32:47]
    buffer_load_dwordx4 v[228:231], v28, s[8:11], s3 offen offset:1024 sc1
    v_mfma_f32_32x32x16_bf16 v[48:63], a[204:207], v[196:199], v[48:63]
    s_waitcnt vmcnt(7)
    v_mfma_f32_32x32x16_bf16 v[32:47], a[208:211], v[200:203], v[32:47]
    buffer_load_dwordx4 v[232:235], v28, s[8:11], s3 offen offset:2048 sc1
    v_mfma_f32_32x32x16_bf16 v[48:63], a[212:215], v[200:203], v[48:63]
    s_waitcnt vmcnt(7)
    v_mfma_f32_32x32x16_bf16 v[32:47], a[216:219], v[204:207], v[32:47]
    buffer_load_dwordx4 v[236:239], v28, s[8:11], s3 offen offset:3072 sc1
    s_add_u32 s3, s3, 0x1000
    s_and_b32 s3, s3, 0xffff
    v_mfma_f32_32x32x16_bf16 v[48:63], a[220:223], v[204:207], v[48:63]
    s_waitcnt vmcnt(7)
    v_mfma_f32_32x32x16_bf16 v[32:47], a[224:227], v[208:211], v[32:47]
    buffer_load_dwordx4 v[240:243], v28, s[8:11], s3 offen offset:0 sc1
    v_mfma_f32_32x32x16_bf16 v[48:63], a[228:231], v[208:211], v[48:63]
    s_waitcnt vmcnt(7)
    v_mfma_f32_32x32x16_bf16 v[32:47], a[232:235], v[212:215], v[32:47]
    buffer_load_dwordx4 v[244:247], v28, s[8:11], s3 offen offset:1024 sc1
    v_mfma_f32_32x32x16_bf16 v[48:63], a[236:239], v[212:215], v[48:63]
    s_waitcnt vmcnt(7)
    v_mfma_f32_32x32x16_bf16 v[32:47], a[240:243], v[216:219], v[32:47]
    buffer_load_dwordx4 v[248:251], v28, s[8:11], s3 offen offset:2048 sc1
    v_mfma_f32_32x32x16_bf16 v[48:63], a[244:247], v[216:219], v[48:63]
    s_waitcnt vmcnt(7)
    v_mfma_f32_32x32x16_bf16 v[32:47], a[248:251], v[220:223], v[32:47]
    buffer_load_dwordx4 v[252:255], v28, s[8:11], s3 offen offset:3072 sc1
    s_add_u32 s3, s3, 0x1000
    s_and_b32 s3, s3, 0xffff
    v_mfma_f32_32x32x16_bf16 v[48:63], a[252:255], v[220:223], v[48:63]
    s_waitcnt vmcnt(7)
    v_mfma_f32_32x32x16_bf16 v[32:47], v[64:67], v[224:227], v[32:47]
    buffer_load_dwordx4 v[192:195], v28, s[8:11], s3 offen offset:0 sc1
    v_mfma_f32_32x32x16_bf16 v[48:63], v[68:71], v[224:227], v[48:63]
    s_waitcnt vmcnt(7)
    v_mfma_f32_32x32x16_bf16 v[32:47], v[72:75], v[228:231], v[32:47]
    buffer_load_dwordx4 v[196:199], v28, s[8:11], s3 offen offset:1024 sc1
    v_mfma_f32_32x32x16_bf16 v[48:63], v[76:79], v[228:231], v[48:63]
    s_waitcnt vmcnt(7)
    v_mfma_f32_32x32x16_bf16 v[32:47], v[80:83], v[232:235], v[32:47]
    buffer_load_dwordx4 v[200:203], v28, s[8:11], s3 offen offset:2048 sc1
    v_mfma_f32_32x32x16_bf16 v[48:63], v[84:87], v[232:235], v[48:63]
    s_waitcnt vmcnt(7)
    v_mfma_f32_32x32x16_bf16 v[32:47], v[88:91], v[236:239], v[32:47]
    buffer_load_dwordx4 v[204:207], v28, s[8:11], s3 offen offset:3072 sc1
    s_add_u32 s3, s3, 0x1000
    s_and_b32 s3, s3, 0xffff
    v_mfma_f32_32x32x16_bf16 v[48:63], v[92:95], v[236:239], v[48:63]
    s_waitcnt vmcnt(7)
    v_mfma_f32_32x32x16_bf16 v[32:47], v[96:99], v[240:243], v[32:47]
    ds_read_b64_tr_b16 v[128:129], v8 offset:0
    ds_read_b64_tr_b16 v[130:131], v8 offset:1024
    buffer_load_dwordx4 v[208:211], v28, s[8:11], s3 offen offset:0 sc1
    v_mfma_f32_32x32x16_bf16 v[48:63], v[100:103], v[240:243], v[48:63]
    ds_read_b64_tr_b16 v[132:133], v9 offset:0
    ds_read_b64_tr_b16 v[134:135], v9 offset:1024
    s_waitcnt vmcnt(7)
    v_mfma_f32_32x32x16_bf16 v[32:47], v[104:107], v[244:247], v[32:47]
    ds_read_b64_tr_b16 v[136:137], v8 offset:2048
    ds_read_b64_tr_b16 v[138:139], v8 offset:3072
    buffer_load_dwordx4 v[212:215], v28, s[8:11], s3 offen offset:1024 sc1
    v_mfma_f32_32x32x16_bf16 v[48:63], v[108:111], v[244:247], v[48:63]
    ds_read_b64_tr_b16 v[140:141], v9 offset:2048
    ds_read_b64_tr_b16 v[142:143], v9 offset:3072
    s_waitcnt vmcnt(7)
    v_mfma_f32_32x32x16_bf16 v[32:47], v[112:115], v[248:251], v[32:47]
    ds_read_b64_tr_b16 v[144:145], v8 offset:4096
    ds_read_b64_tr_b16 v[146:147], v8 offset:5120
    buffer_load_dwordx4 v[216:219], v28, s[8:11], s3 offen offset:2048 sc1
    v_mfma_f32_32x32x16_bf16 v[48:63], v[116:119], v[248:251], v[48:63]
    ds_read_b64_tr_b16 v[148:149], v9 offset:4096
    ds_read_b64_tr_b16 v[150:151], v9 offset:5120
    s_waitcnt vmcnt(7)
    v_mfma_f32_32x32x16_bf16 v[32:47], v[120:123], v[252:255], v[32:47]
    ds_read_b64_tr_b16 v[152:153], v8 offset:6144
    ds_read_b64_tr_b16 v[154:155], v8 offset:7168
    buffer_load_dwordx4 v[220:223], v28, s[8:11], s3 offen offset:3072 sc1
    s_add_u32 s3, s3, 0x1000
    s_and_b32 s3, s3, 0xffff
    v_mfma_f32_32x32x16_bf16 v[48:63], v[124:127], v[252:255], v[48:63]
    ds_read_b64_tr_b16 v[156:157], v9 offset:6144
    ds_read_b64_tr_b16 v[158:159], v9 offset:7168
    s_mov_b32 s54, 0xffff
    s_and_b32 s50, s53, s54
    s_cmp_lg_u32 s50, s54
    s_cbranch_scc1 L_o_poll1
L_o_ready1:
    s_barrier
.p2align 6
L_o_loop:
    s_waitcnt vmcnt(7) lgkmcnt(12)
    v_mfma_f32_32x32x16_bf16 v[32:47], v[128:131], v[192:195], v[32:47]
    ds_read_b64_tr_b16 v[160:161], v8 offset:8192
    ds_read_b64_tr_b16 v[162:163], v8 offset:9216
    buffer_load_dwordx4 v[224:227], v28, s[8:11], s3 offen offset:0 sc1
    v_mfma_f32_32x32x16_bf16 v[48:63], v[132:135], v[192:195], v[48:63]
    ds_read_b64_tr_b16 v[164:165], v9 offset:8192
    ds_read_b64_tr_b16 v[166:167], v9 offset:9216
    s_add_u32 s37, s37, 0x8000
    s_and_b32 s37, s37, 0x1ffff
    s_waitcnt vmcnt(7) lgkmcnt(12)
    v_mfma_f32_32x32x16_bf16 v[32:47], v[136:139], v[196:199], v[32:47]
    ds_read_b64_tr_b16 v[168:169], v8 offset:10240
    ds_read_b64_tr_b16 v[170:171], v8 offset:11264
    buffer_load_dwordx4 v[228:231], v28, s[8:11], s3 offen offset:1024 sc1
    v_mfma_f32_32x32x16_bf16 v[48:63], v[140:143], v[196:199], v[48:63]
    ds_read_b64_tr_b16 v[172:173], v9 offset:10240
    ds_read_b64_tr_b16 v[174:175], v9 offset:11264
    s_cmp_eq_u32 s39, 6
    s_cselect_b32 s37, 0x20000, s37
    s_waitcnt vmcnt(7) lgkmcnt(12)
    v_mfma_f32_32x32x16_bf16 v[32:47], v[144:147], v[200:203], v[32:47]
    ds_read_b64_tr_b16 v[176:177], v8 offset:12288
    ds_read_b64_tr_b16 v[178:179], v8 offset:13312
    buffer_load_dwordx4 v[232:235], v28, s[8:11], s3 offen offset:2048 sc1
    v_mfma_f32_32x32x16_bf16 v[48:63], v[148:151], v[200:203], v[48:63]
    ds_read_b64_tr_b16 v[180:181], v9 offset:12288
    ds_read_b64_tr_b16 v[182:183], v9 offset:13312
    s_waitcnt vmcnt(7) lgkmcnt(12)
    v_mfma_f32_32x32x16_bf16 v[32:47], v[152:155], v[204:207], v[32:47]
    ds_read_b64_tr_b16 v[184:185], v8 offset:14336
    ds_read_b64_tr_b16 v[186:187], v8 offset:15360
    buffer_load_dwordx4 v[236:239], v28, s[8:11], s3 offen offset:3072 sc1
    s_add_u32 s3, s3, 0x1000
    s_and_b32 s3, s3, 0xffff
    v_mfma_f32_32x32x16_bf16 v[48:63], v[156:159], v[204:207], v[48:63]
    ds_read_b64_tr_b16 v[188:189], v9 offset:14336
    ds_read_b64_tr_b16 v[190:191], v9 offset:15360
    s_waitcnt vmcnt(7) lgkmcnt(12)
    v_mfma_f32_32x32x16_bf16 v[32:47], v[160:163], v[208:211], v[32:47]
    ds_read_b64_tr_b16 v[128:129], v8 offset:16384
    ds_read_b64_tr_b16 v[130:131], v8 offset:17408
    buffer_load_dwordx4 v[240:243], v28, s[8:11], s3 offen offset:0 sc1
    v_mfma_f32_32x32x16_bf16 v[48:63], v[164:167], v[208:211], v[48:63]
    ds_read_b64_tr_b16 v[132:133], v9 offset:16384
    ds_read_b64_tr_b16 v[134:135], v9 offset:17408
    s_waitcnt vmcnt(7) lgkmcnt(12)
    v_mfma_f32_32x32x16_bf16 v[32:47], v[168:171], v[212:215], v[32:47]
    ds_read_b64_tr_b16 v[136:137], v8 offset:18432
    ds_read_b64_tr_b16 v[138:139], v8 offset:19456
    buffer_load_dwordx4 v[244:247], v28, s[8:11], s3 offen offset:1024 sc1
    v_mfma_f32_32x32x16_bf16 v[48:63], v[172:175], v[212:215], v[48:63]
    ds_read_b64_tr_b16 v[140:141], v9 offset:18432
    ds_read_b64_tr_b16 v[142:143], v9 offset:19456
    s_waitcnt vmcnt(7) lgkmcnt(12)
    v_mfma_f32_32x32x16_bf16 v[32:47], v[176:179], v[216:219], v[32:47]
    ds_read_b64_tr_b16 v[144:145], v8 offset:20480
    ds_read_b64_tr_b16 v[146:147], v8 offset:21504
    buffer_load_dwordx4 v[248:251], v28, s[8:11], s3 offen offset:2048 sc1
    v_mfma_f32_32x32x16_bf16 v[48:63], v[180:183], v[216:219], v[48:63]
    ds_read_b64_tr_b16 v[148:149], v9 offset:20480
    ds_read_b64_tr_b16 v[150:151], v9 offset:21504
    s_waitcnt vmcnt(7) lgkmcnt(12)
    v_mfma_f32_32x32x16_bf16 v[32:47], v[184:187], v[220:223], v[32:47]
    ds_read_b64_tr_b16 v[152:153], v8 offset:22528
    ds_read_b64_tr_b16 v[154:155], v8 offset:23552
    buffer_load_dwordx4 v[252:255], v28, s[8:11], s3 offen offset:3072 sc1
    s_add_u32 s3, s3, 0x1000
    s_and_b32 s3, s3, 0xffff
    v_mfma_f32_32x32x16_bf16 v[48:63], v[188:191], v[220:223], v[48:63]
    ds_read_b64_tr_b16 v[156:157], v9 offset:22528
    ds_read_b64_tr_b16 v[158:159], v9 offset:23552
    s_mov_b32 s8, s4
    s_mov_b32 s9, s5
    s_cmp_eq_u32 s39, 7
    s_cbranch_scc1 L_o_tail
    s_waitcnt vmcnt(7) lgkmcnt(12)
    v_mfma_f32_32x32x16_bf16 v[32:47], v[128:131], v[224:227], v[32:47]
    ds_read_b64_tr_b16 v[160:161], v8 offset:24576
    ds_read_b64_tr_b16 v[162:163], v8 offset:25600
    buffer_load_dwordx4 v[192:195], v28, s[8:11], s3 offen offset:0 sc1
    v_mfma_f32_32x32x16_bf16 v[48:63], v[132:135], v[224:227], v[48:63]
    ds_read_b64_tr_b16 v[164:165], v9 offset:24576
    ds_read_b64_tr_b16 v[166:167], v9 offset:25600
    s_add_u32 s39, s39, 1
    s_waitcnt vmcnt(7) lgkmcnt(12)
    v_mfma_f32_32x32x16_bf16 v[32:47], v[136:139], v[228:231], v[32:47]
    ds_read_b64_tr_b16 v[168:169], v8 offset:26624
    ds_read_b64_tr_b16 v[170:171], v8 offset:27648
    buffer_load_dwordx4 v[196:199], v28, s[8:11], s3 offen offset:1024 sc1
    v_mfma_f32_32x32x16_bf16 v[48:63], v[140:143], v[228:231], v[48:63]
    ds_read_b64_tr_b16 v[172:173], v9 offset:26624
    ds_read_b64_tr_b16 v[174:175], v9 offset:27648
    s_waitcnt vmcnt(7) lgkmcnt(12)
    v_mfma_f32_32x32x16_bf16 v[32:47], v[144:147], v[232:235], v[32:47]
    ds_read_b64_tr_b16 v[176:177], v8 offset:28672
    ds_read_b64_tr_b16 v[178:179], v8 offset:29696
    buffer_load_dwordx4 v[200:203], v28, s[8:11], s3 offen offset:2048 sc1
    v_mfma_f32_32x32x16_bf16 v[48:63], v[148:151], v[232:235], v[48:63]
    ds_read_b64_tr_b16 v[180:181], v9 offset:28672
    ds_read_b64_tr_b16 v[182:183], v9 offset:29696
    s_waitcnt vmcnt(7) lgkmcnt(12)
    v_mfma_f32_32x32x16_bf16 v[32:47], v[152:155], v[236:239], v[32:47]
    ds_read_b64_tr_b16 v[184:185], v8 offset:30720
    ds_read_b64_tr_b16 v[186:187], v8 offset:31744
    buffer_load_dwordx4 v[204:207], v28, s[8:11], s3 offen offset:3072 sc1
    s_add_u32 s3, s3, 0x1000
    s_and_b32 s3, s3, 0xffff
    v_mfma_f32_32x32x16_bf16 v[48:63], v[156:159], v[236:239], v[48:63]
    ds_read_b64_tr_b16 v[188:189], v9 offset:30720
    ds_read_b64_tr_b16 v[190:191], v9 offset:31744
    v_add_u32 v8, s37, v16
    v_add_u32 v9, s37, v17
    s_waitcnt vmcnt(7) lgkmcnt(12)
    v_mfma_f32_32x32x16_bf16 v[32:47], v[160:163], v[240:243], v[32:47]
    ds_read_b64_tr_b16 v[128:129], v8 offset:0
    ds_read_b64_tr_b16 v[130:131], v8 offset:1024
    buffer_load_dwordx4 v[208:211], v28, s[8:11], s3 offen offset:0 sc1
    v_mfma_f32_32x32x16_bf16 v[48:63], v[164:167], v[240:243], v[48:63]
    ds_read_b64_tr_b16 v[132:133], v9 offset:0
    ds_read_b64_tr_b16 v[134:135], v9 offset:1024
    s_waitcnt vmcnt(7) lgkmcnt(12)
    v_mfma_f32_32x32x16_bf16 v[32:47], v[168:171], v[244:247], v[32:47]
    ds_read_b64_tr_b16 v[136:137], v8 offset:2048
    ds_read_b64_tr_b16 v[138:139], v8 offset:3072
    buffer_load_dwordx4 v[212:215], v28, s[8:11], s3 offen offset:1024 sc1
    v_mfma_f32_32x32x16_bf16 v[48:63], v[172:175], v[244:247], v[48:63]
    ds_read_b64_tr_b16 v[140:141], v9 offset:2048
    ds_read_b64_tr_b16 v[142:143], v9 offset:3072
    s_waitcnt vmcnt(7) lgkmcnt(12)
    v_mfma_f32_32x32x16_bf16 v[32:47], v[176:179], v[248:251], v[32:47]
    ds_read_b64_tr_b16 v[144:145], v8 offset:4096
    ds_read_b64_tr_b16 v[146:147], v8 offset:5120
    buffer_load_dwordx4 v[216:219], v28, s[8:11], s3 offen offset:2048 sc1
    v_mfma_f32_32x32x16_bf16 v[48:63], v[180:183], v[248:251], v[48:63]
    ds_read_b64_tr_b16 v[148:149], v9 offset:4096
    ds_read_b64_tr_b16 v[150:151], v9 offset:5120
    s_waitcnt vmcnt(7) lgkmcnt(12)
    v_mfma_f32_32x32x16_bf16 v[32:47], v[184:187], v[252:255], v[32:47]
    ds_read_b64_tr_b16 v[152:153], v8 offset:6144
    ds_read_b64_tr_b16 v[154:155], v8 offset:7168
    buffer_load_dwordx4 v[220:223], v28, s[8:11], s3 offen offset:3072 sc1
    s_add_u32 s3, s3, 0x1000
    s_and_b32 s3, s3, 0xffff
    v_mfma_f32_32x32x16_bf16 v[48:63], v[188:191], v[252:255], v[48:63]
    ds_read_b64_tr_b16 v[156:157], v9 offset:6144
    ds_read_b64_tr_b16 v[158:159], v9 offset:7168
    s_branch L_o_loop
L_o_tail:
    s_waitcnt vmcnt(7) lgkmcnt(12)
    v_mfma_f32_32x32x16_bf16 v[32:47], v[128:131], v[224:227], v[32:47]
    ds_read_b64_tr_b16 v[160:161], v8 offset:24576
    ds_read_b64_tr_b16 v[162:163], v8 offset:25600
    v_mfma_f32_32x32x16_bf16 v[48:63], v[132:135], v[224:227], v[48:63]
    ds_read_b64_tr_b16 v[164:165], v9 offset:24576
    ds_read_b64_tr_b16 v[166:167], v9 offset:25600
    s_waitcnt vmcnt(6) lgkmcnt(12)
    v_mfma_f32_32x32x16_bf16 v[32:47], v[136:139], v[228:231], v[32:47]
    ds_read_b64_tr_b16 v[168:169], v8 offset:26624
    ds_read_b64_tr_b16 v[170:171], v8 offset:27648
    v_mfma_f32_32x32x16_bf16 v[48:63], v[140:143], v[228:231], v[48:63]
    ds_read_b64_tr_b16 v[172:173], v9 offset:26624
    ds_read_b64_tr_b16 v[174:175], v9 offset:27648
    s_waitcnt vmcnt(5) lgkmcnt(12)
    v_mfma_f32_32x32x16_bf16 v[32:47], v[144:147], v[232:235], v[32:47]
    ds_read_b64_tr_b16 v[176:177], v8 offset:28672
    ds_read_b64_tr_b16 v[178:179], v8 offset:29696
    v_mfma_f32_32x32x16_bf16 v[48:63], v[148:151], v[232:235], v[48:63]
    ds_read_b64_tr_b16 v[180:181], v9 offset:28672
    ds_read_b64_tr_b16 v[182:183], v9 offset:29696
    s_waitcnt vmcnt(4) lgkmcnt(12)
    v_mfma_f32_32x32x16_bf16 v[32:47], v[152:155], v[236:239], v[32:47]
    ds_read_b64_tr_b16 v[184:185], v8 offset:30720
    ds_read_b64_tr_b16 v[186:187], v8 offset:31744
    v_mfma_f32_32x32x16_bf16 v[48:63], v[156:159], v[236:239], v[48:63]
    ds_read_b64_tr_b16 v[188:189], v9 offset:30720
    ds_read_b64_tr_b16 v[190:191], v9 offset:31744
    s_waitcnt vmcnt(3) lgkmcnt(12)
    v_mfma_f32_32x32x16_bf16 v[32:47], v[160:163], v[240:243], v[32:47]
    v_mfma_f32_32x32x16_bf16 v[48:63], v[164:167], v[240:243], v[48:63]
    s_waitcnt vmcnt(2) lgkmcnt(8)
    v_mfma_f32_32x32x16_bf16 v[32:47], v[168:171], v[244:247], v[32:47]
    v_mfma_f32_32x32x16_bf16 v[48:63], v[172:175], v[244:247], v[48:63]
    s_waitcnt vmcnt(1) lgkmcnt(4)
    v_mfma_f32_32x32x16_bf16 v[32:47], v[176:179], v[248:251], v[32:47]
    v_mfma_f32_32x32x16_bf16 v[48:63], v[180:183], v[248:251], v[48:63]
    s_waitcnt vmcnt(0) lgkmcnt(0)
    v_mfma_f32_32x32x16_bf16 v[32:47], v[184:187], v[252:255], v[32:47]
    v_mfma_f32_32x32x16_bf16 v[48:63], v[188:191], v[252:255], v[48:63]
    s_mov_b32 s40, s43
    s_nop 2
    v_lshlrev_b32 v18, 11, v3
    v_lshl_add_u32 v18, v2, 4, v18
    s_nop 7
    v_cvt_pk_bf16_f32 v64, v32, v33
    v_cvt_pk_bf16_f32 v65, v34, v35
    v_cvt_pk_bf16_f32 v66, v36, v37
    v_cvt_pk_bf16_f32 v67, v38, v39
    v_cvt_pk_bf16_f32 v68, v40, v41
    v_cvt_pk_bf16_f32 v69, v42, v43
    v_cvt_pk_bf16_f32 v70, v44, v45
    v_cvt_pk_bf16_f32 v71, v46, v47
    buffer_store_dwordx4 v[64:67], v18, s[56:59], s40 offen offset:0 nt
    buffer_store_dwordx4 v[68:71], v18, s[56:59], s40 offen offset:32 nt
    v_cvt_pk_bf16_f32 v72, v48, v49
    v_cvt_pk_bf16_f32 v73, v50, v51
    v_cvt_pk_bf16_f32 v74, v52, v53
    v_cvt_pk_bf16_f32 v75, v54, v55
    v_cvt_pk_bf16_f32 v76, v56, v57
    v_cvt_pk_bf16_f32 v77, v58, v59
    v_cvt_pk_bf16_f32 v78, v60, v61
    v_cvt_pk_bf16_f32 v79, v62, v63
    buffer_store_dwordx4 v[72:75], v18, s[56:59], s40 offen offset:64 nt
    buffer_store_dwordx4 v[76:79], v18, s[56:59], s40 offen offset:96 nt
    s_endpgm
L_o_poll1:
    s_mov_b32 s48, 0
L_o_spin1:
    buffer_load_dword v27, v18, s[16:19], s6 offen sc1
    s_waitcnt vmcnt(0)
    v_cmp_eq_u32 vcc, 1, v27
    s_add_u32 s48, s48, 1
    s_cmp_gt_u32 s48, 0x40000
    s_cbranch_scc1 L_o_ready1
    s_nop 2
    s_mov_b32 s53, vcc_lo
    s_and_b32 s50, s53, s54
    s_cmp_eq_u32 s50, s54
    s_cbranch_scc1 L_o_ready1
    s_sleep 2
    s_branch L_o_spin1
L_o_poll0:
    s_mov_b32 s48, 0
L_o_spin0:
    buffer_load_dword v27, v18, s[16:19], s6 offen sc1
    s_waitcnt vmcnt(0)
    v_cmp_eq_u32 vcc, 1, v27
    s_add_u32 s48, s48, 1
    s_cmp_gt_u32 s48, 0x40000
    s_cbranch_scc1 L_o_ready0
    s_nop 2
    s_mov_b32 s53, vcc_lo
    s_and_b32 s50, s53, s54
    s_cmp_eq_u32 s50, s54
    s_cbranch_scc1 L_o_ready0
    s_sleep 2
    s_branch L_o_spin0
L_at_slow:
    s_waitcnt vmcnt(0) lgkmcnt(0)
    s_lshl_b32 s39, s28, 18
    s_add_u32 s44, s26, s39
    s_addc_u32 s45, s27, 0
    s_mov_b32 s46, 0x40000
    v_mov_b32 v160, 0xff7fffff
    v_mov_b32 v161, 0xff7fffff
    v_mov_b32 v162, 0xff7fffff
    v_mov_b32 v163, 0xff7fffff
    s_mov_b32 s39, 0
L_at_slow1:
    buffer_load_dwordx4 a[16:19], v28, s[44:47], s39 offen sc1
    buffer_load_dwordx4 a[20:23], v28, s[44:47], s39 offen offset:1024 sc1
    s_waitcnt vmcnt(0)
    v_mfma_f32_32x32x16_bf16 v[32:47], a[16:19], v[224:227], 0
    v_mfma_f32_32x32x16_bf16 v[32:47], a[20:23], v[228:231], v[32:47]
    v_mfma_f32_32x32x16_bf16 v[48:63], a[16:19], v[232:235], 0
    v_mfma_f32_32x32x16_bf16 v[48:63], a[20:23], v[236:239], v[48:63]
    v_mfma_f32_32x32x16_bf16 v[64:79], a[16:19], v[240:243], 0
    v_mfma_f32_32x32x16_bf16 v[64:79], a[20:23], v[244:247], v[64:79]
    v_mfma_f32_32x32x16_bf16 v[80:95], a[16:19], v[248:251], 0
    v_mfma_f32_32x32x16_bf16 v[80:95], a[20:23], v[252:255], v[80:95]
    s_nop 15
    v_max3_f32 v160, v160, v32, v33
    v_max3_f32 v160, v160, v34, v35
    v_max3_f32 v160, v160, v36, v37
    v_max3_f32 v160, v160, v38, v39
    v_max3_f32 v160, v160, v40, v41
    v_max3_f32 v160, v160, v42, v43
    v_max3_f32 v160, v160, v44, v45
    v_max3_f32 v160, v160, v46, v47
    v_max3_f32 v161, v161, v48, v49
    v_max3_f32 v161, v161, v50, v51
    v_max3_f32 v161, v161, v52, v53
    v_max3_f32 v161, v161, v54, v55
    v_max3_f32 v161, v161, v56, v57
    v_max3_f32 v161, v161, v58, v59
    v_max3_f32 v161, v161, v60, v61
    v_max3_f32 v161, v161, v62, v63
    v_max3_f32 v162, v162, v64, v65
    v_max3_f32 v162, v162, v66, v67
    v_max3_f32 v162, v162, v68, v69
    v_max3_f32 v162, v162, v70, v71
    v_max3_f32 v162, v162, v72, v73
    v_max3_f32 v162, v162, v74, v75
    v_max3_f32 v162, v162, v76, v77
    v_max3_f32 v162, v162, v78, v79
    v_max3_f32 v163, v163, v80, v81
    v_max3_f32 v163, v163, v82, v83
    v_max3_f32 v163, v163, v84, v85
    v_max3_f32 v163, v163, v86, v87
    v_max3_f32 v163, v163, v88, v89
    v_max3_f32 v163, v163, v90, v91
    v_max3_f32 v163, v163, v92, v93
    v_max3_f32 v163, v163, v94, v95
    s_add_u32 s39, s39, 0x1000
    s_cmp_lt_u32 s39, 0x40000
    s_cbranch_scc1 L_at_slow1
    v_mov_b32 v32, v160
    v_mov_b32 v33, v32
    s_nop 1
    v_permlane32_swap_b32 v32, v33
    s_nop 1
    v_max_f32 v32, v32, v33
    v_sub_f32 v96, 0, v32
    v_sub_f32 v97, 0, v32
    v_mov_b64 v[98:99], v[96:97]
    v_mov_b64 v[100:101], v[96:97]
    v_mov_b64 v[102:103], v[96:97]
    v_mov_b64 v[104:105], v[96:97]
    v_mov_b64 v[106:107], v[96:97]
    v_mov_b64 v[108:109], v[96:97]
    v_mov_b64 v[110:111], v[96:97]
    v_mov_b32 v48, v161
    v_mov_b32 v49, v48
    s_nop 1
    v_permlane32_swap_b32 v48, v49
    s_nop 1
    v_max_f32 v48, v48, v49
    v_sub_f32 v112, 0, v48
    v_sub_f32 v113, 0, v48
    v_mov_b64 v[114:115], v[112:113]
    v_mov_b64 v[116:117], v[112:113]
    v_mov_b64 v[118:119], v[112:113]
    v_mov_b64 v[120:121], v[112:113]
    v_mov_b64 v[122:123], v[112:113]
    v_mov_b64 v[124:125], v[112:113]
    v_mov_b64 v[126:127], v[112:113]
    v_mov_b32 v64, v162
    v_mov_b32 v65, v64
    s_nop 1
    v_permlane32_swap_b32 v64, v65
    s_nop 1
    v_max_f32 v64, v64, v65
    v_sub_f32 v128, 0, v64
    v_sub_f32 v129, 0, v64
    v_mov_b64 v[130:131], v[128:129]
    v_mov_b64 v[132:133], v[128:129]
    v_mov_b64 v[134:135], v[128:129]
    v_mov_b64 v[136:137], v[128:129]
    v_mov_b64 v[138:139], v[128:129]
    v_mov_b64 v[140:141], v[128:129]
    v_mov_b64 v[142:143], v[128:129]
    v_mov_b32 v80, v163
    v_mov_b32 v81, v80
    s_nop 1
    v_permlane32_swap_b32 v80, v81
    s_nop 1
    v_max_f32 v80, v80, v81
    v_sub_f32 v144, 0, v80
    v_sub_f32 v145, 0, v80
    v_mov_b64 v[146:147], v[144:145]
    v_mov_b64 v[148:149], v[144:145]
    v_mov_b64 v[150:151], v[144:145]
    v_mov_b64 v[152:153], v[144:145]
    v_mov_b64 v[154:155], v[144:145]
    v_mov_b64 v[156:157], v[144:145]
    v_mov_b64 v[158:159], v[144:145]
    v_accvgpr_write_b32 a0, 0
    v_accvgpr_write_b32 a1, 0
    v_accvgpr_write_b32 a2, 0
    v_accvgpr_write_b32 a3, 0
    v_accvgpr_write_b32 a4, 0
    v_accvgpr_write_b32 a5, 0
    v_accvgpr_write_b32 a6, 0
    v_accvgpr_write_b32 a7, 0
    v_accvgpr_write_b32 a8, 0
    v_accvgpr_write_b32 a9, 0
    v_accvgpr_write_b32 a10, 0
    v_accvgpr_write_b32 a11, 0
    v_accvgpr_write_b32 a12, 0
    v_accvgpr_write_b32 a13, 0
    v_accvgpr_write_b32 a14, 0
    v_accvgpr_write_b32 a15, 0
    v_mov_b32 v160, 0
    v_mov_b32 v161, 0
    v_mov_b32 v162, 0
    v_mov_b32 v163, 0
    v_mov_b32 v164, 0
    v_mov_b32 v165, 0
    v_mov_b32 v166, 0
    v_mov_b32 v167, 0
    v_mov_b32 v168, 0
    v_mov_b32 v169, 0
    v_mov_b32 v170, 0
    v_mov_b32 v171, 0
    v_mov_b32 v172, 0
    v_mov_b32 v173, 0
    v_mov_b32 v174, 0
    v_mov_b32 v175, 0
    v_mov_b32 v176, 0
    v_mov_b32 v177, 0
    v_mov_b32 v178, 0
    v_mov_b32 v179, 0
    v_mov_b32 v180, 0
    v_mov_b32 v181, 0
    v_mov_b32 v182, 0
    v_mov_b32 v183, 0
    v_mov_b32 v184, 0
    v_mov_b32 v185, 0
    v_mov_b32 v186, 0
    v_mov_b32 v187, 0
    v_mov_b32 v188, 0
    v_mov_b32 v189, 0
    v_mov_b32 v190, 0
    v_mov_b32 v191, 0
    v_mov_b32 v192, 0
    v_mov_b32 v193, 0
    v_mov_b32 v194, 0
    v_mov_b32 v195, 0
    v_mov_b32 v196, 0
    v_mov_b32 v197, 0
    v_mov_b32 v198, 0
    v_mov_b32 v199, 0
    v_mov_b32 v200, 0
    v_mov_b32 v201, 0
    v_mov_b32 v202, 0
    v_mov_b32 v203, 0
    v_mov_b32 v204, 0
    v_mov_b32 v205, 0
    v_mov_b32 v206, 0
    v_mov_b32 v207, 0
    v_mov_b32 v208, 0
    v_mov_b32 v209, 0
    v_mov_b32 v210, 0
    v_mov_b32 v211, 0
    v_mov_b32 v212, 0
    v_mov_b32 v213, 0
    v_mov_b32 v214, 0
    v_mov_b32 v215, 0
    v_mov_b32 v216, 0
    v_mov_b32 v217, 0
    v_mov_b32 v218, 0
    v_mov_b32 v219, 0
    v_mov_b32 v220, 0
    v_mov_b32 v221, 0
    v_mov_b32 v222, 0
    v_mov_b32 v223, 0
    s_mov_b32 s39, 0
L_at_slow2:
    buffer_load_dwordx4 a[16:19], v28, s[44:47], s39 offen sc1
    buffer_load_dwordx4 a[20:23], v28, s[44:47], s39 offen offset:1024 sc1
    buffer_load_dwordx4 a[32:35], v28, s[44:47], s39 offen offset:2048 sc1
    buffer_load_dwordx4 a[36:39], v28, s[44:47], s39 offen offset:3072 sc1
    s_waitcnt vmcnt(0)
    v_mfma_f32_32x32x16_bf16 v[32:47], a[16:19], v[224:227], v[96:111]
    v_mfma_f32_32x32x16_bf16 v[32:47], a[20:23], v[228:231], v[32:47]
    v_mfma_f32_32x32x16_bf16 v[48:63], a[16:19], v[232:235], v[112:127]
    v_mfma_f32_32x32x16_bf16 v[48:63], a[20:23], v[236:239], v[48:63]
    v_mfma_f32_32x32x16_bf16 v[64:79], a[16:19], v[240:243], v[128:143]
    v_mfma_f32_32x32x16_bf16 v[64:79], a[20:23], v[244:247], v[64:79]
    v_mfma_f32_32x32x16_bf16 v[80:95], a[16:19], v[248:251], v[144:159]
    v_mfma_f32_32x32x16_bf16 v[80:95], a[20:23], v[252:255], v[80:95]
    s_nop 15
    v_exp_f32 v32, v32
    v_exp_f32 v33, v33
    v_exp_f32 v34, v34
    v_exp_f32 v35, v35
    v_exp_f32 v36, v36
    v_exp_f32 v37, v37
    v_exp_f32 v38, v38
    v_exp_f32 v39, v39
    v_exp_f32 v40, v40
    v_exp_f32 v41, v41
    v_exp_f32 v42, v42
    v_exp_f32 v43, v43
    v_exp_f32 v44, v44
    v_exp_f32 v45, v45
    v_exp_f32 v46, v46
    v_exp_f32 v47, v47
    v_exp_f32 v48, v48
    v_exp_f32 v49, v49
    v_exp_f32 v50, v50
    v_exp_f32 v51, v51
    v_exp_f32 v52, v52
    v_exp_f32 v53, v53
    v_exp_f32 v54, v54
    v_exp_f32 v55, v55
    v_exp_f32 v56, v56
    v_exp_f32 v57, v57
    v_exp_f32 v58, v58
    v_exp_f32 v59, v59
    v_exp_f32 v60, v60
    v_exp_f32 v61, v61
    v_exp_f32 v62, v62
    v_exp_f32 v63, v63
    v_exp_f32 v64, v64
    v_exp_f32 v65, v65
    v_exp_f32 v66, v66
    v_exp_f32 v67, v67
    v_exp_f32 v68, v68
    v_exp_f32 v69, v69
    v_exp_f32 v70, v70
    v_exp_f32 v71, v71
    v_exp_f32 v72, v72
    v_exp_f32 v73, v73
    v_exp_f32 v74, v74
    v_exp_f32 v75, v75
    v_exp_f32 v76, v76
    v_exp_f32 v77, v77
    v_exp_f32 v78, v78
    v_exp_f32 v79, v79
    v_exp_f32 v80, v80
    v_exp_f32 v81, v81
    v_exp_f32 v82, v82
    v_exp_f32 v83, v83
    v_exp_f32 v84, v84
    v_exp_f32 v85, v85
    v_exp_f32 v86, v86
    v_exp_f32 v87, v87
    v_exp_f32 v88, v88
    v_exp_f32 v89, v89
    v_exp_f32 v90, v90
    v_exp_f32 v91, v91
    v_exp_f32 v92, v92
    v_exp_f32 v93, v93
    v_exp_f32 v94, v94
    v_exp_f32 v95, v95
    s_nop 1
    v_smfmac_f32_32x32x32_bf16 v[160:175], a[32:35], v[32:39], v23
    v_smfmac_f32_32x32x32_bf16 v[160:175], a[36:39], v[40:47], v23
    v_smfmac_f32_16x16x64_bf16 a[0:3], a[48:51], v[32:39], v23
    v_smfmac_f32_16x16x64_bf16 a[0:3], a[48:51], v[40:47], v23
    v_smfmac_f32_32x32x32_bf16 v[176:191], a[32:35], v[48:55], v23
    v_smfmac_f32_32x32x32_bf16 v[176:191], a[36:39], v[56:63], v23
    v_smfmac_f32_16x16x64_bf16 a[4:7], a[48:51], v[48:55], v23
    v_smfmac_f32_16x16x64_bf16 a[4:7], a[48:51], v[56:63], v23
    v_smfmac_f32_32x32x32_bf16 v[192:207], a[32:35], v[64:71], v23
    v_smfmac_f32_32x32x32_bf16 v[192:207], a[36:39], v[72:79], v23
    v_smfmac_f32_16x16x64_bf16 a[8:11], a[48:51], v[64:71], v23
    v_smfmac_f32_16x16x64_bf16 a[8:11], a[48:51], v[72:79], v23
    v_smfmac_f32_32x32x32_bf16 v[208:223], a[32:35], v[80:87], v23
    v_smfmac_f32_32x32x32_bf16 v[208:223], a[36:39], v[88:95], v23
    v_smfmac_f32_16x16x64_bf16 a[12:15], a[48:51], v[80:87], v23
    v_smfmac_f32_16x16x64_bf16 a[12:15], a[48:51], v[88:95], v23
    s_nop 15
    s_add_u32 s39, s39, 0x1000
    s_cmp_lt_u32 s39, 0x40000
    s_cbranch_scc1 L_at_slow2
    s_nop 15
    v_accvgpr_read_b32 v24, a0
    v_accvgpr_read_b32 v25, a0
    s_nop 1
    v_permlane32_swap_b32 v24, v25
    s_nop 1
    v_add_f32 v31, v31, v24
    v_rcp_f32 v24, v24
    s_nop 0
    v_mul_f32 v24, v24, v26
    v_pk_mul_f32 v[160:161], v[160:161], v[24:25] op_sel_hi:[1,0]
    v_pk_mul_f32 v[162:163], v[162:163], v[24:25] op_sel_hi:[1,0]
    v_pk_mul_f32 v[164:165], v[164:165], v[24:25] op_sel_hi:[1,0]
    v_pk_mul_f32 v[166:167], v[166:167], v[24:25] op_sel_hi:[1,0]
    v_pk_mul_f32 v[168:169], v[168:169], v[24:25] op_sel_hi:[1,0]
    v_pk_mul_f32 v[170:171], v[170:171], v[24:25] op_sel_hi:[1,0]
    v_pk_mul_f32 v[172:173], v[172:173], v[24:25] op_sel_hi:[1,0]
    v_pk_mul_f32 v[174:175], v[174:175], v[24:25] op_sel_hi:[1,0]
    v_cvt_pk_bf16_f32 v96, v160, v161
    v_cvt_pk_bf16_f32 v97, v162, v163
    v_cvt_pk_bf16_f32 v98, v164, v165
    v_cvt_pk_bf16_f32 v99, v166, v167
    v_cvt_pk_bf16_f32 v100, v168, v169
    v_cvt_pk_bf16_f32 v101, v170, v171
    v_cvt_pk_bf16_f32 v102, v172, v173
    v_cvt_pk_bf16_f32 v103, v174, v175
    buffer_store_dwordx4 v[96:99], v28, s[16:19], s40 offen offset:0 sc1
    buffer_store_dwordx4 v[100:103], v28, s[16:19], s40 offen offset:1024 sc1
    v_accvgpr_read_b32 v24, a4
    v_accvgpr_read_b32 v25, a4
    s_nop 1
    v_permlane32_swap_b32 v24, v25
    s_nop 1
    v_add_f32 v31, v31, v24
    v_rcp_f32 v24, v24
    s_nop 0
    v_mul_f32 v24, v24, v27
    v_pk_mul_f32 v[176:177], v[176:177], v[24:25] op_sel_hi:[1,0]
    v_pk_mul_f32 v[178:179], v[178:179], v[24:25] op_sel_hi:[1,0]
    v_pk_mul_f32 v[180:181], v[180:181], v[24:25] op_sel_hi:[1,0]
    v_pk_mul_f32 v[182:183], v[182:183], v[24:25] op_sel_hi:[1,0]
    v_pk_mul_f32 v[184:185], v[184:185], v[24:25] op_sel_hi:[1,0]
    v_pk_mul_f32 v[186:187], v[186:187], v[24:25] op_sel_hi:[1,0]
    v_pk_mul_f32 v[188:189], v[188:189], v[24:25] op_sel_hi:[1,0]
    v_pk_mul_f32 v[190:191], v[190:191], v[24:25] op_sel_hi:[1,0]
    v_cvt_pk_bf16_f32 v112, v176, v177
    v_cvt_pk_bf16_f32 v113, v178, v179
    v_cvt_pk_bf16_f32 v114, v180, v181
    v_cvt_pk_bf16_f32 v115, v182, v183
    v_cvt_pk_bf16_f32 v116, v184, v185
    v_cvt_pk_bf16_f32 v117, v186, v187
    v_cvt_pk_bf16_f32 v118, v188, v189
    v_cvt_pk_bf16_f32 v119, v190, v191
    buffer_store_dwordx4 v[112:115], v28, s[16:19], s41 offen offset:0 sc1
    buffer_store_dwordx4 v[116:119], v28, s[16:19], s41 offen offset:1024 sc1
    v_accvgpr_read_b32 v24, a8
    v_accvgpr_read_b32 v25, a8
    s_nop 1
    v_permlane32_swap_b32 v24, v25
    s_nop 1
    v_add_f32 v31, v31, v24
    v_rcp_f32 v24, v24
    s_nop 0
    v_mul_f32 v24, v24, v26
    v_pk_mul_f32 v[192:193], v[192:193], v[24:25] op_sel_hi:[1,0]
    v_pk_mul_f32 v[194:195], v[194:195], v[24:25] op_sel_hi:[1,0]
    v_pk_mul_f32 v[196:197], v[196:197], v[24:25] op_sel_hi:[1,0]
    v_pk_mul_f32 v[198:199], v[198:199], v[24:25] op_sel_hi:[1,0]
    v_pk_mul_f32 v[200:201], v[200:201], v[24:25] op_sel_hi:[1,0]
    v_pk_mul_f32 v[202:203], v[202:203], v[24:25] op_sel_hi:[1,0]
    v_pk_mul_f32 v[204:205], v[204:205], v[24:25] op_sel_hi:[1,0]
    v_pk_mul_f32 v[206:207], v[206:207], v[24:25] op_sel_hi:[1,0]
    v_cvt_pk_bf16_f32 v128, v192, v193
    v_cvt_pk_bf16_f32 v129, v194, v195
    v_cvt_pk_bf16_f32 v130, v196, v197
    v_cvt_pk_bf16_f32 v131, v198, v199
    v_cvt_pk_bf16_f32 v132, v200, v201
    v_cvt_pk_bf16_f32 v133, v202, v203
    v_cvt_pk_bf16_f32 v134, v204, v205
    v_cvt_pk_bf16_f32 v135, v206, v207
    buffer_store_dwordx4 v[128:131], v28, s[16:19], s40 offen offset:2048 sc1
    buffer_store_dwordx4 v[132:135], v28, s[16:19], s40 offen offset:3072 sc1
    v_accvgpr_read_b32 v24, a12
    v_accvgpr_read_b32 v25, a12
    s_nop 1
    v_permlane32_swap_b32 v24, v25
    s_nop 1
    v_add_f32 v31, v31, v24
    v_rcp_f32 v24, v24
    s_nop 0
    v_mul_f32 v24, v24, v27
    v_pk_mul_f32 v[208:209], v[208:209], v[24:25] op_sel_hi:[1,0]
    v_pk_mul_f32 v[210:211], v[210:211], v[24:25] op_sel_hi:[1,0]
    v_pk_mul_f32 v[212:213], v[212:213], v[24:25] op_sel_hi:[1,0]
    v_pk_mul_f32 v[214:215], v[214:215], v[24:25] op_sel_hi:[1,0]
    v_pk_mul_f32 v[216:217], v[216:217], v[24:25] op_sel_hi:[1,0]
    v_pk_mul_f32 v[218:219], v[218:219], v[24:25] op_sel_hi:[1,0]
    v_pk_mul_f32 v[220:221], v[220:221], v[24:25] op_sel_hi:[1,0]
    v_pk_mul_f32 v[222:223], v[222:223], v[24:25] op_sel_hi:[1,0]
    v_cvt_pk_bf16_f32 v144, v208, v209
    v_cvt_pk_bf16_f32 v145, v210, v211
    v_cvt_pk_bf16_f32 v146, v212, v213
    v_cvt_pk_bf16_f32 v147, v214, v215
    v_cvt_pk_bf16_f32 v148, v216, v217
    v_cvt_pk_bf16_f32 v149, v218, v219
    v_cvt_pk_bf16_f32 v150, v220, v221
    v_cvt_pk_bf16_f32 v151, v222, v223
    buffer_store_dwordx4 v[144:147], v28, s[16:19], s41 offen offset:2048 sc1
    buffer_store_dwordx4 v[148:151], v28, s[16:19], s41 offen offset:3072 sc1
    s_branch L_at_done
L_at_end:
    s_endpgm
L_code_end:
.section .rodata,"a"
.p2align 6
.amdhsa_kernel gated_mix__grouped_kv_mqa__grouped_kv_mqa__prompt_kernel
  .amdhsa_next_free_vgpr 512
  .amdhsa_next_free_sgpr 102
  .amdhsa_accum_offset 256
  .amdhsa_group_segment_fixed_size 0
  .amdhsa_kernarg_size 112
  .amdhsa_user_sgpr_count 2
  .amdhsa_user_sgpr_kernarg_segment_ptr 1
  .amdhsa_system_sgpr_workgroup_id_x 1
.end_amdhsa_kernel
```
